```python
import torch

def _softmax(x, axis=-1):
    return torch.softmax(x, dim=axis)
def _gelu(x):
    return torch.nn.functional.gelu(x, approximate="tanh")
def _silu(x):
    return torch.nn.functional.silu(x)
def _sigmoid(x):
    return torch.sigmoid(x)
def _layernorm(x, axis=-1, eps=1e-5):
    m = x.mean(dim=axis, keepdim=True)
    v = x.var(dim=axis, keepdim=True, unbiased=False)
    return (x - m) / torch.sqrt(v + eps)
def _scatter_add(tgt, idx, src, axis=0):
    return tgt.clone().index_add_(axis, idx, src)
def _segment_sum(src, seg, n):
    out = torch.zeros((n,) + src.shape[1:], dtype=src.dtype)
    return out.index_add_(0, seg, src)
def _pad(x, pw):
    flat = tuple(v for pair in reversed(pw) for v in pair)
    return torch.nn.functional.pad(x, flat)

kernel_name = 'interleave_layers__sliding_block_cached__moe_arch_mod__decode'

def setup_inputs():

    _w = (lambda a: (lambda t: t.to(torch.bfloat16) if t.is_floating_point() else t)(torch.as_tensor(a)))
    def _A_setup():
        B, Sq, D = 4, 1, 640
        Hq, Hkv, Sk, Dh = 32, 32, 4096, 192
        assert Hq % Hkv == 0, (Hq, Hkv)
        return {
            "x": _w((lambda *s: torch.randn(*s, dtype=torch.bfloat16) * 0.05)(B, Sq, D)),
            "k_cache": _w((lambda *s: torch.randn(*s, dtype=torch.bfloat16) * 1.6)(B, Hkv, Sk, Dh)),
            "v_cache": _w((lambda *s: torch.randn(*s, dtype=torch.bfloat16) * 1.6)(B, Hkv, Sk, Dh)),
            "wq": _w((lambda *s: torch.randn(*s, dtype=torch.bfloat16) * 1.6)(D, Hq * Dh) * (D ** -0.5)),
            "wo": _w((lambda *s: torch.randn(*s, dtype=torch.bfloat16) * 1.6)(Hq * Dh, D) * ((Hq * Dh) ** -0.5)),
        }
    _A_in = _A_setup()

    def _B_setup():
        B, S, D, F, C = 4, 1, 640, 1536, 1
        return {
            "x": _w((lambda *s: torch.randn(*s, dtype=torch.bfloat16) * 0.05)(B, S, D)),
            "w_r": _w((lambda *s: torch.randn(*s, dtype=torch.bfloat16) * 0.05)(D)),
            "w_gate": _w((lambda *s: torch.randn(*s, dtype=torch.bfloat16) * 0.05)(D, F)),
            "w_up": _w((lambda *s: torch.randn(*s, dtype=torch.bfloat16) * 0.05)(D, F)),
            "w_down": _w((lambda *s: torch.randn(*s, dtype=torch.bfloat16) * 0.05)(F, D)),
        }
    _B_in = _B_setup()

    return {
        "A_x": _A_in["x"],
        "A_k_cache": _A_in["k_cache"],
        "A_v_cache": _A_in["v_cache"],
        "A_wq": _A_in["wq"],
        "A_wo": _A_in["wo"],
        "B_x": _B_in["x"],
        "B_w_r": _B_in["w_r"],
        "B_w_gate": _B_in["w_gate"],
        "B_w_up": _B_in["w_up"],
        "B_w_down": _B_in["w_down"],
    }

def reference(A_x, A_k_cache, A_v_cache, A_wq, A_wo, B_x, B_w_r, B_w_gate, B_w_up, B_w_down):
    def _A_ref(x, k_cache, v_cache, wq, wo):
        B, Sq, D = x.shape
        Hq, Dh = 32, 192
        Hkv, Sk = k_cache.shape[1], k_cache.shape[2]
        W = min(4096, max(256, Sk // 4))
        rep = Hq // Hkv
        q = (lambda x, *d: x.permute(*d))((x @ wq).reshape(B, Sq, Hq, Dh), 0, 2, 1, 3)
        k = (lambda x, n, axis: torch.repeat_interleave(x, n, dim=axis))(k_cache[:, :, Sk - W:, :], rep, axis=1)
        v = (lambda x, n, axis: torch.repeat_interleave(x, n, dim=axis))(v_cache[:, :, Sk - W:, :], rep, axis=1)
        scores = torch.einsum("bhqd,bhkd->bhqk", q, k) * (Dh ** -0.5)
        p = _softmax(scores, axis=-1)
        o = torch.einsum("bhqk,bhkd->bhqd", p, v)
        return (lambda x, *d: x.permute(*d))(o, 0, 2, 1, 3).reshape(B, Sq, Hq * Dh) @ wo

    def _B_ref(x, w_r, w_gate, w_up, w_down):
        B, S, D = x.shape
        C = 1
        r = x @ w_r
        idx = torch.argsort(-r, axis=-1)[:, :C]
        idx_e = (lambda x, n, axis: torch.repeat_interleave(x, n, dim=axis))(idx.reshape(B, C, 1), D, axis=2)
        x_sel = (lambda x, i, axis: torch.take_along_dim(x, i, dim=axis))(x, idx_e, axis=1)
        g = _silu(x_sel @ w_gate)
        u = x_sel @ w_up
        y = (g * u) @ w_down
        r_sel = _sigmoid((lambda x, i, axis: torch.take_along_dim(x, i, dim=axis))(r, idx, axis=1))
        y = y * r_sel.reshape(B, C, 1)
        b_off = (torch.arange(B) * S).reshape(B, 1)
        flat_idx = (idx + b_off).reshape(B * C)
        zero = (x * 0.0).reshape(B * S, D)
        upd = _scatter_add(zero, flat_idx, y.reshape(B * C, D), axis=0)
        return x + upd.reshape(B, S, D)

    x = A_x
    x = x + _A_ref(_layernorm(x, axis=-1), A_k_cache, A_v_cache, A_wq, A_wo)
    x = x + _B_ref(_layernorm(x, axis=-1), B_w_r, B_w_gate, B_w_up, B_w_down)
    x = x + _A_ref(_layernorm(x, axis=-1), A_k_cache, A_v_cache, A_wq, A_wo)
    x = x + _B_ref(_layernorm(x, axis=-1), B_w_r, B_w_gate, B_w_up, B_w_down)
    return x
```

```asm
; @launch grid=(256,1,1) block=(512,1,1) lds=162944
.amdgcn_target "amdgcn-amd-amdhsa--gfx950"
.text
.globl interleave_layers__sliding_block_cached__moe_arch_mod__decode_kernel
.p2align 8
.type interleave_layers__sliding_block_cached__moe_arch_mod__decode_kernel,@function
interleave_layers__sliding_block_cached__moe_arch_mod__decode_kernel:
    s_cmp_ge_u32 s2, 256
    s_cbranch_scc1 L_exit
    s_load_dwordx16 s[64:79], s[0:1], 0
    s_load_dwordx8 s[80:87], s[0:1], 64
    s_load_dwordx2 s[88:89], s[0:1], 96
    v_lshrrev_b32 v1, 6, v0
    v_and_b32 v0, 63, v0
    v_readfirstlane_b32 s3, v1
    v_mov_b32 v4, 0
    v_mov_b32 v5, 0
    v_mov_b32 v6, 0
    v_mov_b32 v7, 0
    v_lshlrev_b32 v1, 4, v0
    s_mov_b64 exec, 7
    ds_write_b128 v1, v[4:7] offset:16672
    s_mov_b64 exec, -1
    s_and_b32 s4, s2, 7
    s_lshr_b32 s5, s2, 3
    s_lshr_b32 s62, s5, 3
    s_lshl_b32 s63, s4, 2
    s_add_u32 s92, s62, s63
    s_bfe_u32 s62, s5, 0x20001
    s_lshl_b32 s62, s62, 5
    s_add_u32 s62, s62, s92
    s_lshl_b32 s62, s62, 12
    s_and_b32 s63, s5, 1
    s_lshl_b32 s63, s63, 9
    s_add_u32 s62, s62, s63
    s_lshl_b32 s63, s3, 6
    s_add_u32 s62, s62, s63
    s_add_u32 s62, s62, 3072
    s_mul_i32 s90, s62, 384
    s_mov_b32 s6, 0
    s_mov_b32 s7, 0
    s_mov_b64 s[60:61], -1
    s_mov_b32 s58, 0x100000
    s_mov_b32 s56, 0
    s_mov_b32 s93, 0x3fb8aa3b
    s_mov_b32 s94, 0x3d93cd3a
    s_mov_b32 s95, 0x3acccccd
    s_mov_b32 s59, 0x3727c5ac
    s_lshl_b32 s54, s4, 5
    s_add_u32 s54, s54, s5
    s_mul_i32 s55, s4, 30
    s_add_u32 s55, s55, s5
    s_mul_i32 s53, s5, 26
    s_lshr_b32 s53, s53, 8
    s_mul_i32 s62, s53, 10
    s_sub_u32 s52, s5, s62
    s_min_u32 s53, s53, 2
    s_mov_b32 s62, 0x21010101
    s_mov_b32 s63, 0xa160606
    s_lshl_b32 s91, s3, 3
    s_lshr_b64 s[62:63], s[62:63], s91
    s_and_b32 s57, s62, 0xff
    v_bfe_u32 v84, v0, 1, 3
    v_mul_u32_u24 v84, 384, v84
    v_lshrrev_b32 v3, 4, v0
    v_lshl_add_u32 v84, v3, 5, v84
    v_and_b32 v3, 1, v0
    v_lshl_add_u32 v84, v3, 4, v84
    v_lshrrev_b32 v85, 5, v0
    v_lshlrev_b32 v85, 3, v85
    v_bfe_u32 v3, v0, 3, 2
    v_add_u32 v85, v85, v3
    v_mul_u32_u24 v85, 384, v85
    v_and_b32 v3, 7, v0
    v_lshl_add_u32 v85, v3, 4, v85
    s_waitcnt lgkmcnt(0)
    s_barrier
    s_add_u32 s62, s88, 3276800
    s_addc_u32 s63, s89, 0
    s_load_dword s101, s[62:63], 0
    s_add_u32 s8, s66, s90
    s_addc_u32 s9, s67, 0
    s_mov_b32 s10, 24576
    s_mov_b32 s11, 0x20000
    s_add_u32 s12, s68, s90
    s_addc_u32 s13, s69, 0
    s_mov_b32 s14, 24576
    s_mov_b32 s15, 0x20000
    s_bitcmp1_b32 s57, 1
    s_cbranch_scc1 L_start_hi
    s_mov_b32 s62, 0
    buffer_load_dwordx4 a[0:3], v84, s[8:11], s62 offen offset:0 nt
    buffer_load_dwordx4 a[4:7], v84, s[8:11], s62 offen offset:128 nt
    buffer_load_dwordx4 a[16:19], v84, s[8:11], s62 offen offset:256 nt
    s_mov_b32 s62, 3072
    buffer_load_dwordx4 a[8:11], v84, s[8:11], s62 offen offset:0 nt
    buffer_load_dwordx4 a[12:15], v84, s[8:11], s62 offen offset:128 nt
    buffer_load_dwordx4 a[20:23], v84, s[8:11], s62 offen offset:256 nt
    s_mov_b32 s62, 6144
    buffer_load_dwordx4 a[24:27], v84, s[8:11], s62 offen offset:0 nt
    buffer_load_dwordx4 a[28:31], v84, s[8:11], s62 offen offset:128 nt
    buffer_load_dwordx4 a[40:43], v84, s[8:11], s62 offen offset:256 nt
    s_mov_b32 s62, 9216
    buffer_load_dwordx4 a[32:35], v84, s[8:11], s62 offen offset:0 nt
    buffer_load_dwordx4 a[36:39], v84, s[8:11], s62 offen offset:128 nt
    buffer_load_dwordx4 a[44:47], v84, s[8:11], s62 offen offset:256 nt
    s_mov_b32 s62, 12288
    buffer_load_dwordx4 a[48:51], v84, s[8:11], s62 offen offset:0 nt
    buffer_load_dwordx4 a[52:55], v84, s[8:11], s62 offen offset:128 nt
    buffer_load_dwordx4 a[64:67], v84, s[8:11], s62 offen offset:256 nt
    s_mov_b32 s62, 15360
    buffer_load_dwordx4 a[56:59], v84, s[8:11], s62 offen offset:0 nt
    buffer_load_dwordx4 a[60:63], v84, s[8:11], s62 offen offset:128 nt
    buffer_load_dwordx4 a[68:71], v84, s[8:11], s62 offen offset:256 nt
    s_mov_b32 s62, 18432
    buffer_load_dwordx4 a[72:75], v84, s[8:11], s62 offen offset:0 nt
    buffer_load_dwordx4 a[76:79], v84, s[8:11], s62 offen offset:128 nt
    buffer_load_dwordx4 a[88:91], v84, s[8:11], s62 offen offset:256 nt
    s_mov_b32 s62, 21504
    buffer_load_dwordx4 a[80:83], v84, s[8:11], s62 offen offset:0 nt
    buffer_load_dwordx4 a[84:87], v84, s[8:11], s62 offen offset:128 nt
    buffer_load_dwordx4 a[92:95], v84, s[8:11], s62 offen offset:256 nt
    s_mov_b32 s16, s88
    s_mov_b32 s17, s89
    s_mov_b32 s18, 3540992
    s_mov_b32 s19, 0x20000
    s_mul_i32 s62, s52, 786432
    s_mul_i32 s63, s4, 3
    s_add_u32 s91, s63, s53
    s_lshl_b32 s63, s91, 9
    s_add_u32 s62, s62, s63
    s_add_u32 s20, s70, s62
    s_addc_u32 s21, s71, 0
    s_sub_u32 s22, 7864320, s62
    s_mov_b32 s23, 0x20000
    s_mul_i32 s62, s91, 327680
    s_lshl_b32 s90, s52, 7
    s_add_u32 s62, s62, s90
    s_add_u32 s24, s72, s62
    s_addc_u32 s25, s73, 0
    s_sub_u32 s26, 7864320, s62
    s_mov_b32 s27, 0x20000
    s_mul_i32 s62, s91, 81920
    s_add_u32 s62, s62, s90
    s_add_u32 s36, s82, s62
    s_addc_u32 s37, s83, 0
    s_sub_u32 s38, 1966080, s62
    s_mov_b32 s39, 0x20000
    s_mul_i32 s62, s52, 196608
    s_lshl_b32 s63, s91, 7
    s_add_u32 s62, s62, s63
    s_add_u32 s28, s78, s62
    s_addc_u32 s29, s79, 0
    s_sub_u32 s30, 1966080, s62
    s_mov_b32 s31, 0x20000
    s_add_u32 s32, s80, s62
    s_addc_u32 s33, s81, 0
    s_sub_u32 s34, 1966080, s62
    s_mov_b32 s35, 0x20000
    s_mov_b32 s40, s64
    s_mov_b32 s41, s65
    s_mov_b32 s42, 5120
    s_mov_b32 s43, 0x20000
    s_add_u32 s44, s76, s90
    s_addc_u32 s45, s77, 0
    s_sub_u32 s46, 1280, s90
    s_mov_b32 s47, 0x20000
    s_mov_b32 s48, s84
    s_mov_b32 s49, s85
    s_mov_b32 s50, 5120
    s_mov_b32 s51, 0x20000
    s_waitcnt lgkmcnt(0)
    s_add_u32 s101, s101, 1
    s_cmp_ge_u32 s5, 30
    s_cbranch_scc1 L_now_1
    v_lshrrev_b32 v1, 3, v0
    v_mul_u32_u24 v4, 1280, v1
    v_bfe_u32 v1, v0, 4, 1
    v_bfe_u32 v2, v0, 1, 2
    v_xor_b32 v1, v1, v2
    v_lshl_add_u32 v4, v1, 5, v4
    v_and_b32 v1, 1, v0
    v_lshl_add_u32 v4, v1, 4, v4
    v_xor_b32 v5, 64, v4
    s_lshl_b32 s62, s3, 3
    s_mov_b32 s63, 0x0
    s_lshr_b32 s89, s63, s62
    s_and_b32 s89, s89, 0xff
    s_mov_b32 s63, 0x0
    s_lshr_b32 s91, s63, s62
    s_and_b32 s91, s91, 0xff
    s_lshl_b32 s63, s91, 10
L_now_1:
    s_mul_i32 s63, s3, 6144
    s_add_u32 m0, s63, 113792
    s_mov_b32 s62, 0
    buffer_load_dwordx4 v85, s[12:15], s62 offen nt lds
    s_add_u32 m0, s63, 115840
    s_mov_b32 s62, 128
    buffer_load_dwordx4 v85, s[12:15], s62 offen nt lds
    s_add_u32 m0, s63, 117888
    s_mov_b32 s62, 256
    buffer_load_dwordx4 v85, s[12:15], s62 offen nt lds
    s_add_u32 m0, s63, 114816
    s_mov_b32 s62, 6144
    buffer_load_dwordx4 v85, s[12:15], s62 offen nt lds
    s_add_u32 m0, s63, 116864
    s_mov_b32 s62, 6272
    buffer_load_dwordx4 v85, s[12:15], s62 offen nt lds
    s_add_u32 m0, s63, 118912
    s_mov_b32 s62, 6400
    buffer_load_dwordx4 v85, s[12:15], s62 offen nt lds
    s_mov_b32 s62, 1536
    buffer_load_dwordx4 v[88:91], v85, s[12:15], s62 offen offset:0 nt
    buffer_load_dwordx4 v[96:99], v85, s[12:15], s62 offen offset:128 nt
    buffer_load_dwordx4 v[104:107], v85, s[12:15], s62 offen offset:256 nt
    s_mov_b32 s62, 7680
    buffer_load_dwordx4 v[92:95], v85, s[12:15], s62 offen offset:0 nt
    buffer_load_dwordx4 v[100:103], v85, s[12:15], s62 offen offset:128 nt
    buffer_load_dwordx4 v[108:111], v85, s[12:15], s62 offen offset:256 nt
    s_mov_b32 s62, 12288
    buffer_load_dwordx4 v[112:115], v85, s[12:15], s62 offen offset:0 nt
    buffer_load_dwordx4 v[120:123], v85, s[12:15], s62 offen offset:128 nt
    buffer_load_dwordx4 v[128:131], v85, s[12:15], s62 offen offset:256 nt
    s_mov_b32 s62, 18432
    buffer_load_dwordx4 v[116:119], v85, s[12:15], s62 offen offset:0 nt
    buffer_load_dwordx4 v[124:127], v85, s[12:15], s62 offen offset:128 nt
    buffer_load_dwordx4 v[132:135], v85, s[12:15], s62 offen offset:256 nt
    s_mov_b32 s62, 13824
    buffer_load_dwordx4 v[136:139], v85, s[12:15], s62 offen offset:0 nt
    buffer_load_dwordx4 v[144:147], v85, s[12:15], s62 offen offset:128 nt
    buffer_load_dwordx4 v[152:155], v85, s[12:15], s62 offen offset:256 nt
    s_mov_b32 s62, 19968
    buffer_load_dwordx4 v[140:143], v85, s[12:15], s62 offen offset:0 nt
    buffer_load_dwordx4 v[148:151], v85, s[12:15], s62 offen offset:128 nt
    buffer_load_dwordx4 v[156:159], v85, s[12:15], s62 offen offset:256 nt
    s_cmp_eq_u32 s3, 3
    s_cbranch_scc0 L_nog_3
    s_setprio 3
    s_bfe_u32 s63, s5, 0x20001
    s_lshl_b32 s88, s63, 10
    v_lshrrev_b32 v1, 4, v0
    v_mul_u32_u24 v78, 5248, v1
    v_and_b32 v3, 15, v0
    v_lshl_add_u32 v78, v3, 4, v78
    v_add_u32 v78, s88, v78
    s_mul_i32 s89, s101, 0x01010101
    v_mov_b32 v72, s89
    v_lshrrev_b32 v73, 8, v72
    v_lshrrev_b32 v74, 16, v72
    v_lshrrev_b32 v75, 24, v72
    v_bfe_u32 v1, v0, 3, 1
    v_lshlrev_b32 v79, 6, v1
    v_bfe_u32 v1, v0, 1, 1
    v_lshl_add_u32 v79, v1, 5, v79
    v_lshrrev_b32 v1, 5, v0
    v_lshl_add_u32 v79, v1, 4, v79
    v_bfe_u32 v1, v0, 2, 1
    v_lshl_add_u32 v79, v1, 3, v79
    v_and_b32 v1, 1, v0
    v_lshl_add_u32 v79, v1, 2, v79
    v_bfe_u32 v1, v0, 4, 1
    v_lshl_add_u32 v79, v1, 1, v79
    s_lshr_b32 s62, s5, 3
    s_mul_i32 s62, s62, 3
    s_add_u32 s62, s62, 0
    s_lshr_b32 s63, s62, 2
    s_mul_i32 s63, s63, 10
    s_lshl_b32 s88, s4, 5
    s_add_u32 s63, s63, s88
    s_mul_i32 s63, s63, 5248
    s_and_b32 s62, s62, 3
    s_lshl_b32 s62, s62, 8
    s_add_u32 s63, s63, s62
    s_add_u32 s88, s63, 1900544
    s_lshr_b32 s62, s5, 3
    s_mul_i32 s62, s62, 3
    s_add_u32 s62, s62, 1
    s_lshr_b32 s63, s62, 2
    s_mul_i32 s63, s63, 10
    s_lshl_b32 s90, s4, 5
    s_add_u32 s63, s63, s90
    s_mul_i32 s63, s63, 5248
    s_and_b32 s62, s62, 3
    s_lshl_b32 s62, s62, 8
    s_add_u32 s63, s63, s62
    s_add_u32 s90, s63, 1900544
    s_lshr_b32 s62, s5, 3
    s_mul_i32 s62, s62, 3
    s_add_u32 s62, s62, 2
    s_lshr_b32 s63, s62, 2
    s_mul_i32 s63, s63, 10
    s_lshl_b32 s91, s4, 5
    s_add_u32 s63, s63, s91
    s_mul_i32 s63, s63, 5248
    s_and_b32 s62, s62, 3
    s_lshl_b32 s62, s62, 8
    s_add_u32 s63, s63, s62
    s_add_u32 s91, s63, 1900544
    v_add_u32 v77, 20992, v78
    v_add_u32 v76, 41984, v78
    v_mov_b32 v3, 2146435072
    v_cmp_gt_u32 vcc, 32, v0
    s_nop 1
    v_cndmask_b32 v76, v3, v76, vcc
L_tq_4:
    buffer_load_dwordx4 v[4:7], v78, s[16:19], s88 offen sc1
    buffer_load_dwordx4 v[16:19], v78, s[16:19], s90 offen sc1
    buffer_load_dwordx4 v[28:31], v78, s[16:19], s91 offen sc1
    buffer_load_dwordx4 v[8:11], v77, s[16:19], s88 offen sc1
    buffer_load_dwordx4 v[20:23], v77, s[16:19], s90 offen sc1
    buffer_load_dwordx4 v[32:35], v77, s[16:19], s91 offen sc1
    buffer_load_dwordx4 v[12:15], v76, s[16:19], s88 offen sc1
    buffer_load_dwordx4 v[24:27], v76, s[16:19], s90 offen sc1
    buffer_load_dwordx4 v[36:39], v76, s[16:19], s91 offen sc1
    v_mov_b32 v1, 0
    s_waitcnt vmcnt(0)
    v_xor_b32 v2, v72, v4
    v_xor_b32 v3, v73, v5
    v_or3_b32 v1, v1, v2, v3
    v_xor_b32 v2, v74, v6
    v_xor_b32 v3, v75, v7
    v_or3_b32 v1, v1, v2, v3
    v_and_b32 v4, 0xffffff00, v4
    v_and_b32 v5, 0xffffff00, v5
    v_and_b32 v6, 0xffffff00, v6
    v_and_b32 v7, 0xffffff00, v7
    v_xor_b32 v2, v72, v8
    v_xor_b32 v3, v73, v9
    v_or3_b32 v1, v1, v2, v3
    v_xor_b32 v2, v74, v10
    v_xor_b32 v3, v75, v11
    v_or3_b32 v1, v1, v2, v3
    v_and_b32 v8, 0xffffff00, v8
    v_and_b32 v9, 0xffffff00, v9
    v_and_b32 v10, 0xffffff00, v10
    v_and_b32 v11, 0xffffff00, v11
    v_xor_b32 v2, v72, v16
    v_xor_b32 v3, v73, v17
    v_or3_b32 v1, v1, v2, v3
    v_xor_b32 v2, v74, v18
    v_xor_b32 v3, v75, v19
    v_or3_b32 v1, v1, v2, v3
    v_and_b32 v16, 0xffffff00, v16
    v_and_b32 v17, 0xffffff00, v17
    v_and_b32 v18, 0xffffff00, v18
    v_and_b32 v19, 0xffffff00, v19
    v_xor_b32 v2, v72, v20
    v_xor_b32 v3, v73, v21
    v_or3_b32 v1, v1, v2, v3
    v_xor_b32 v2, v74, v22
    v_xor_b32 v3, v75, v23
    v_or3_b32 v1, v1, v2, v3
    v_and_b32 v20, 0xffffff00, v20
    v_and_b32 v21, 0xffffff00, v21
    v_and_b32 v22, 0xffffff00, v22
    v_and_b32 v23, 0xffffff00, v23
    v_xor_b32 v2, v72, v28
    v_xor_b32 v3, v73, v29
    v_or3_b32 v1, v1, v2, v3
    v_xor_b32 v2, v74, v30
    v_xor_b32 v3, v75, v31
    v_or3_b32 v1, v1, v2, v3
    v_and_b32 v28, 0xffffff00, v28
    v_and_b32 v29, 0xffffff00, v29
    v_and_b32 v30, 0xffffff00, v30
    v_and_b32 v31, 0xffffff00, v31
    v_xor_b32 v2, v72, v32
    v_xor_b32 v3, v73, v33
    v_or3_b32 v1, v1, v2, v3
    v_xor_b32 v2, v74, v34
    v_xor_b32 v3, v75, v35
    v_or3_b32 v1, v1, v2, v3
    v_and_b32 v32, 0xffffff00, v32
    v_and_b32 v33, 0xffffff00, v33
    v_and_b32 v34, 0xffffff00, v34
    v_and_b32 v35, 0xffffff00, v35
    s_mov_b32 exec_hi, 0
    v_xor_b32 v2, v72, v12
    v_xor_b32 v3, v73, v13
    v_or3_b32 v1, v1, v2, v3
    v_xor_b32 v2, v74, v14
    v_xor_b32 v3, v75, v15
    v_or3_b32 v1, v1, v2, v3
    v_and_b32 v12, 0xffffff00, v12
    v_and_b32 v13, 0xffffff00, v13
    v_and_b32 v14, 0xffffff00, v14
    v_and_b32 v15, 0xffffff00, v15
    v_xor_b32 v2, v72, v24
    v_xor_b32 v3, v73, v25
    v_or3_b32 v1, v1, v2, v3
    v_xor_b32 v2, v74, v26
    v_xor_b32 v3, v75, v27
    v_or3_b32 v1, v1, v2, v3
    v_and_b32 v24, 0xffffff00, v24
    v_and_b32 v25, 0xffffff00, v25
    v_and_b32 v26, 0xffffff00, v26
    v_and_b32 v27, 0xffffff00, v27
    v_xor_b32 v2, v72, v36
    v_xor_b32 v3, v73, v37
    v_or3_b32 v1, v1, v2, v3
    v_xor_b32 v2, v74, v38
    v_xor_b32 v3, v75, v39
    v_or3_b32 v1, v1, v2, v3
    v_and_b32 v36, 0xffffff00, v36
    v_and_b32 v37, 0xffffff00, v37
    v_and_b32 v38, 0xffffff00, v38
    v_and_b32 v39, 0xffffff00, v39
    v_add_f32 v4, v4, v12
    v_add_f32 v5, v5, v13
    v_add_f32 v6, v6, v14
    v_add_f32 v7, v7, v15
    v_add_f32 v16, v16, v24
    v_add_f32 v17, v17, v25
    v_add_f32 v18, v18, v26
    v_add_f32 v19, v19, v27
    v_add_f32 v28, v28, v36
    v_add_f32 v29, v29, v37
    v_add_f32 v30, v30, v38
    v_add_f32 v31, v31, v39
    s_mov_b64 exec, -1
    v_and_b32 v1, 0xff, v1
    v_cmp_ne_u32 vcc, 0, v1
    s_cbranch_vccnz L_tqr_5
    v_add_f32 v4, v4, v8
    v_add_f32 v5, v5, v9
    v_add_f32 v6, v6, v10
    v_add_f32 v7, v7, v11
    s_nop 0
    v_permlane32_swap_b32 v4, v6
    v_permlane32_swap_b32 v5, v7
    v_add_f32 v4, v4, v6
    v_add_f32 v5, v5, v7
    s_nop 1
    v_permlane16_swap_b32 v4, v5
    v_add_f32 v4, v4, v5
    v_cvt_pk_bf16_f32 v4, 0, v4
    ds_write_b16_d16_hi v79, v4 offset:16288
    v_add_f32 v16, v16, v20
    v_add_f32 v17, v17, v21
    v_add_f32 v18, v18, v22
    v_add_f32 v19, v19, v23
    s_nop 0
    v_permlane32_swap_b32 v16, v18
    v_permlane32_swap_b32 v17, v19
    v_add_f32 v16, v16, v18
    v_add_f32 v17, v17, v19
    s_nop 1
    v_permlane16_swap_b32 v16, v17
    v_add_f32 v16, v16, v17
    v_cvt_pk_bf16_f32 v16, 0, v16
    ds_write_b16_d16_hi v79, v16 offset:16416
    v_add_f32 v28, v28, v32
    v_add_f32 v29, v29, v33
    v_add_f32 v30, v30, v34
    v_add_f32 v31, v31, v35
    s_nop 0
    v_permlane32_swap_b32 v28, v30
    v_permlane32_swap_b32 v29, v31
    v_add_f32 v28, v28, v30
    v_add_f32 v29, v29, v31
    s_nop 1
    v_permlane16_swap_b32 v28, v29
    v_add_f32 v28, v28, v29
    v_cvt_pk_bf16_f32 v28, 0, v28
    ds_write_b16_d16_hi v79, v28 offset:16544
    v_mov_b32 v5, 16688
L_sp_7:
    ds_read_b32 v4, v5 offset:4
    s_waitcnt lgkmcnt(0)
    v_cmp_gt_u32 vcc, 8, v4
    s_cbranch_vccnz L_spr_8
    v_mov_b32 v4, 1
    ds_write_b32 v5, v4
    s_setprio 0
L_nog_3:
    v_lshrrev_b32 v1, 4, v0
    v_and_b32 v2, 3, v0
    v_lshlrev_b32 v2, 4, v2
    v_lshl_add_u32 v76, v1, 6, v2
    v_and_b32 v3, 0x40, v76
    v_add3_u32 v77, v3, v2, 64
    v_add_u32 v77, 192, v77
    v_bfe_u32 v2, v0, 2, 2
    v_mov_b32 v3, 384
    v_cmp_eq_u32 vcc, 0, v2
    s_nop 1
    v_cndmask_b32 v72, v3, v76, vcc
    v_cmp_eq_u32 vcc, 1, v2
    s_nop 1
    v_cndmask_b32 v73, v3, v76, vcc
    v_cmp_eq_u32 vcc, 2, v2
    s_nop 1
    v_cndmask_b32 v74, v3, v76, vcc
    v_cmp_eq_u32 vcc, 3, v2
    s_nop 1
    v_cndmask_b32 v75, v3, v76, vcc
    v_lshrrev_b32 v1, 5, v0
    v_cmp_eq_u32 vcc, v1, v2
    s_nop 1
    v_cndmask_b32 v76, v3, v77, vcc
    v_add_u32 v1, 2, v1
    v_cmp_eq_u32 vcc, v1, v2
    s_nop 1
    v_cndmask_b32 v77, v3, v77, vcc
    v_and_b32 v1, 1, v0
    v_mul_u32_u24 v78, 0xaaaa, v1
    v_add_u32 v78, 0x4444, v78
    v_and_b32 v1, 3, v0
    v_xor_b32 v2, 1, v1
    v_lshl_add_u32 v79, v2, 2, v1
    v_mul_u32_u24 v79, 0x1111, v79
    v_bfe_u32 v1, v0, 2, 1
    v_mul_u32_u24 v85, 0xffff, v1
    v_sub_u32 v84, 0xffff, v85
    s_mul_i32 s62, s3, 6144
    s_add_u32 s62, s62, 113792
    v_lshl_add_u32 v86, v0, 4, s62
    v_and_b32 v1, 7, v0
    v_lshlrev_b32 v1, 5, v1
    v_bfe_u32 v2, v0, 4, 1
    v_lshl_add_u32 v1, v2, 4, v1
    v_lshrrev_b32 v2, 5, v0
    v_mul_u32_u24 v2, 768, v2
    s_mul_i32 s62, s3, 1536
    v_add3_u32 v87, v1, v2, s62
    v_mov_b32 v28, 0
    v_mov_b32 v29, 0
    v_mov_b32 v30, 0
    v_mov_b32 v31, 0
    v_mov_b32 v32, 0
    v_mov_b32 v33, 0
    v_mov_b32 v34, 0
    v_mov_b32 v35, 0
    v_mov_b32 v36, 0
    v_mov_b32 v37, 0
    v_mov_b32 v38, 0
    v_mov_b32 v39, 0
    v_mov_b32 v40, 0
    v_mov_b32 v41, 0
    v_mov_b32 v42, 0
    v_mov_b32 v43, 0
    v_mov_b32 v44, 0
    v_mov_b32 v45, 0
    v_mov_b32 v46, 0
    v_mov_b32 v47, 0
    s_mov_b32 s47, s101
    s_mov_b32 s40, 81920
    s_mov_b32 s41, 163840
    s_mov_b32 s42, 10752
    s_mov_b32 s43, 20992
    v_mov_b32 v5, 16688
L_sp_9:
    ds_read_b32 v4, v5 offset:0
    s_waitcnt lgkmcnt(0)
    v_cmp_gt_u32 vcc, 1, v4
    s_cbranch_vccnz L_spr_10
    v_lshrrev_b32 v1, 4, v0
    v_mul_u32_u24 v3, 1280, v1
    v_and_b32 v2, 7, v0
    v_lshl_add_u32 v3, v2, 1, v3
    s_lshl_b32 s62, s52, 7
    s_lshl_b32 s63, s3, 4
    s_add_u32 s62, s62, s63
    v_add_u32 v3, s62, v3
    v_mov_b32 v80, 0
    ds_read_u16_d16_hi v80, v3 offset:18512
    s_branch L_attn
L_start_hi:
    s_setprio 3
    s_mov_b32 s16, s88
    s_mov_b32 s17, s89
    s_mov_b32 s18, 3540992
    s_mov_b32 s19, 0x20000
    s_mul_i32 s62, s52, 786432
    s_mul_i32 s63, s4, 3
    s_add_u32 s91, s63, s53
    s_lshl_b32 s63, s91, 9
    s_add_u32 s62, s62, s63
    s_add_u32 s20, s70, s62
    s_addc_u32 s21, s71, 0
    s_sub_u32 s22, 7864320, s62
    s_mov_b32 s23, 0x20000
    s_mul_i32 s62, s91, 327680
    s_lshl_b32 s90, s52, 7
    s_add_u32 s62, s62, s90
    s_add_u32 s24, s72, s62
    s_addc_u32 s25, s73, 0
    s_sub_u32 s26, 7864320, s62
    s_mov_b32 s27, 0x20000
    s_mul_i32 s62, s91, 81920
    s_add_u32 s62, s62, s90
    s_add_u32 s36, s82, s62
    s_addc_u32 s37, s83, 0
    s_sub_u32 s38, 1966080, s62
    s_mov_b32 s39, 0x20000
    s_mul_i32 s62, s52, 196608
    s_lshl_b32 s63, s91, 7
    s_add_u32 s62, s62, s63
    s_add_u32 s28, s78, s62
    s_addc_u32 s29, s79, 0
    s_sub_u32 s30, 1966080, s62
    s_mov_b32 s31, 0x20000
    s_add_u32 s32, s80, s62
    s_addc_u32 s33, s81, 0
    s_sub_u32 s34, 1966080, s62
    s_mov_b32 s35, 0x20000
    s_mov_b32 s40, s64
    s_mov_b32 s41, s65
    s_mov_b32 s42, 5120
    s_mov_b32 s43, 0x20000
    s_add_u32 s44, s76, s90
    s_addc_u32 s45, s77, 0
    s_sub_u32 s46, 1280, s90
    s_mov_b32 s47, 0x20000
    s_mov_b32 s48, s84
    s_mov_b32 s49, s85
    s_mov_b32 s50, 5120
    s_mov_b32 s51, 0x20000
    s_waitcnt lgkmcnt(0)
    s_add_u32 s101, s101, 1
    v_lshlrev_b32 v10, 4, v0
    s_and_b32 s63, s3, 3
    s_lshl_b32 s62, s63, 10
    s_add_u32 m0, s62, 18512
    s_cmp_eq_u32 s3, 4
    buffer_load_dwordx4 v10, s[40:43], s62 offen lds
    s_cbranch_scc0 L_x0_11
    s_mov_b32 m0, 22608
    s_movk_i32 s62, 0x1000
    buffer_load_dwordx4 v10, s[40:43], s62 offen lds
L_x0_11:
    s_cmp_eq_u32 s3, 5
    s_cbranch_scc0 L_x0_12
    s_mov_b32 m0, 13072
    s_mov_b64 exec, 0xff
    buffer_load_dwordx4 v10, s[44:47], 0 offen lds
    s_mov_b64 exec, -1
L_x0_12:
    s_cmp_ge_u32 s5, 30
    s_cbranch_scc1 L_noq_13
    v_lshrrev_b32 v1, 3, v0
    v_mul_u32_u24 v6, 12288, v1
    v_bfe_u32 v1, v0, 4, 1
    v_bfe_u32 v2, v0, 1, 2
    v_xor_b32 v1, v1, v2
    v_lshl_add_u32 v6, v1, 5, v6
    v_and_b32 v1, 1, v0
    v_lshl_add_u32 v6, v1, 4, v6
    v_xor_b32 v7, 64, v6
    s_and_b32 s63, s3, 3
    s_lshl_b32 s88, s63, 7
    s_lshl_b32 s63, s63, 13
    s_add_u32 m0, s63, 81024
    s_add_u32 s62, s88, 0
    buffer_load_dwordx4 v6, s[20:23], s62 offen nt lds
    s_add_u32 m0, s63, 82048
    s_add_u32 s62, s88, 98304
    buffer_load_dwordx4 v7, s[20:23], s62 offen nt lds
    s_add_u32 m0, s63, 83072
    s_add_u32 s62, s88, 196608
    buffer_load_dwordx4 v6, s[20:23], s62 offen nt lds
    s_add_u32 m0, s63, 84096
    s_add_u32 s62, s88, 294912
    buffer_load_dwordx4 v7, s[20:23], s62 offen nt lds
    s_add_u32 m0, s63, 85120
    s_add_u32 s62, s88, 393216
    buffer_load_dwordx4 v6, s[20:23], s62 offen nt lds
    s_add_u32 m0, s63, 86144
    s_add_u32 s62, s88, 491520
    buffer_load_dwordx4 v7, s[20:23], s62 offen nt lds
    s_add_u32 m0, s63, 87168
    s_add_u32 s62, s88, 589824
    buffer_load_dwordx4 v6, s[20:23], s62 offen nt lds
    s_add_u32 m0, s63, 88192
    s_add_u32 s62, s88, 688128
    buffer_load_dwordx4 v7, s[20:23], s62 offen nt lds
    v_lshrrev_b32 v1, 4, v0
    v_and_b32 v2, 15, v0
    v_mul_u32_u24 v3, 1280, v1
    v_lshl_add_u32 v10, v2, 4, v3
    v_lshl_add_u32 v11, v2, 3, v3
    s_lshl_b32 s62, s52, 7
    v_add_u32 v11, s62, v11
    v_mul_u32_u24 v12, 144, v1
    v_lshl_add_u32 v12, v2, 3, v12
    v_lshlrev_b32 v13, 3, v2
    s_waitcnt vmcnt(8)
    v_mov_b32 v4, 16688
    v_mov_b32 v5, 1
    s_mov_b64 exec, 1
    ds_add_u32 v4, v5 offset:4
    s_mov_b64 exec, -1
    v_mov_b32 v5, 16688
L_sp_15:
    ds_read_b32 v4, v5 offset:4
    s_waitcnt lgkmcnt(0)
    v_cmp_gt_u32 vcc, 4, v4
    s_cbranch_vccnz L_spr_16
    ds_read_b128 v[16:19], v10 offset:18512
    ds_read_b128 v[20:23], v10 offset:18768
    ds_read_b128 v[24:27], v10 offset:19024
    ds_read_b128 v[28:31], v10 offset:19280
    ds_read_b128 v[32:35], v10 offset:19536
    ds_read_b64 v[36:37], v11 offset:18512
    v_mov_b32 v40, 0x3f803f80
    v_mov_b32 v41, 0x3f803f80
    v_mov_b32 v42, 0
    v_mov_b32 v43, 0
    s_waitcnt lgkmcnt(0)
    v_dot2_f32_bf16 v42, v16, v16, v42
    v_dot2_f32_bf16 v43, v16, v40, v43
    v_dot2_f32_bf16 v42, v17, v17, v42
    v_dot2_f32_bf16 v43, v17, v40, v43
    v_dot2_f32_bf16 v42, v18, v18, v42
    v_dot2_f32_bf16 v43, v18, v40, v43
    v_dot2_f32_bf16 v42, v19, v19, v42
    v_dot2_f32_bf16 v43, v19, v40, v43
    v_dot2_f32_bf16 v42, v20, v20, v42
    v_dot2_f32_bf16 v43, v20, v40, v43
    v_dot2_f32_bf16 v42, v21, v21, v42
    v_dot2_f32_bf16 v43, v21, v40, v43
    v_dot2_f32_bf16 v42, v22, v22, v42
    v_dot2_f32_bf16 v43, v22, v40, v43
    v_dot2_f32_bf16 v42, v23, v23, v42
    v_dot2_f32_bf16 v43, v23, v40, v43
    v_dot2_f32_bf16 v42, v24, v24, v42
    v_dot2_f32_bf16 v43, v24, v40, v43
    v_dot2_f32_bf16 v42, v25, v25, v42
    v_dot2_f32_bf16 v43, v25, v40, v43
    v_dot2_f32_bf16 v42, v26, v26, v42
    v_dot2_f32_bf16 v43, v26, v40, v43
    v_dot2_f32_bf16 v42, v27, v27, v42
    v_dot2_f32_bf16 v43, v27, v40, v43
    v_dot2_f32_bf16 v42, v28, v28, v42
    v_dot2_f32_bf16 v43, v28, v40, v43
    v_dot2_f32_bf16 v42, v29, v29, v42
    v_dot2_f32_bf16 v43, v29, v40, v43
    v_dot2_f32_bf16 v42, v30, v30, v42
    v_dot2_f32_bf16 v43, v30, v40, v43
    v_dot2_f32_bf16 v42, v31, v31, v42
    v_dot2_f32_bf16 v43, v31, v40, v43
    v_dot2_f32_bf16 v42, v32, v32, v42
    v_dot2_f32_bf16 v43, v32, v40, v43
    v_dot2_f32_bf16 v42, v33, v33, v42
    v_dot2_f32_bf16 v43, v33, v40, v43
    v_dot2_f32_bf16 v42, v34, v34, v42
    v_dot2_f32_bf16 v43, v34, v40, v43
    v_dot2_f32_bf16 v42, v35, v35, v42
    v_dot2_f32_bf16 v43, v35, v40, v43
    s_nop 1
    v_add_f32_dpp v42, v42, v42 quad_perm:[1,0,3,2] row_mask:0xf bank_mask:0xf
    v_add_f32_dpp v43, v43, v43 quad_perm:[1,0,3,2] row_mask:0xf bank_mask:0xf
    s_nop 0
    v_add_f32_dpp v42, v42, v42 quad_perm:[2,3,0,1] row_mask:0xf bank_mask:0xf
    v_add_f32_dpp v43, v43, v43 quad_perm:[2,3,0,1] row_mask:0xf bank_mask:0xf
    s_nop 0
    v_add_f32_dpp v42, v42, v42 row_half_mirror row_mask:0xf bank_mask:0xf
    v_add_f32_dpp v43, v43, v43 row_half_mirror row_mask:0xf bank_mask:0xf
    s_nop 0
    v_add_f32_dpp v42, v42, v42 row_mirror row_mask:0xf bank_mask:0xf
    v_add_f32_dpp v43, v43, v43 row_mirror row_mask:0xf bank_mask:0xf
    v_mul_f32 v43, s95, v43
    v_mul_f32 v42, s95, v42
    v_fma_f32 v46, -v43, v43, v42
    v_cvt_pk_bf16_f32 v44, 0, v43
    v_max_f32 v46, 0, v46
    v_cvt_pk_bf16_f32 v46, 0, v46
    v_add_f32 v46, s59, v46
    v_cvt_pk_bf16_f32 v46, 0, v46
    v_sqrt_f32 v46, v46
    s_nop 0
    v_cvt_pk_bf16_f32 v46, 0, v46
    v_rcp_f32 v45, v46
    v_lshlrev_b32 v16, 16, v36
    v_and_b32 v17, 0xffff0000, v36
    v_lshlrev_b32 v18, 16, v37
    v_and_b32 v19, 0xffff0000, v37
    v_sub_f32 v16, v16, v44
    v_sub_f32 v17, v17, v44
    v_sub_f32 v18, v18, v44
    v_sub_f32 v19, v19, v44
    v_cvt_pk_bf16_f32 v16, 0, v16
    v_cvt_pk_bf16_f32 v17, 0, v17
    v_cvt_pk_bf16_f32 v18, 0, v18
    v_cvt_pk_bf16_f32 v19, 0, v19
    v_mul_f32 v16, v16, v45
    v_mul_f32 v17, v17, v45
    v_mul_f32 v18, v18, v45
    v_mul_f32 v19, v19, v45
    v_cvt_pk_bf16_f32 v16, v16, v17
    v_cvt_pk_bf16_f32 v17, v18, v19
    ds_write_b64 v12, v[16:17] offset:12352
    ds_write_b64 v13, v[40:41] offset:12928
    s_and_b32 s62, s3, 3
    s_lshl_b32 s62, s62, 13
    s_add_u32 s62, s62, 81024
    v_lshrrev_b32 v1, 4, v0
    v_bfe_u32 v2, v0, 2, 2
    v_lshl_add_u32 v52, v1, 3, v2
    v_lshlrev_b32 v52, 7, v52
    v_and_b32 v2, 3, v0
    v_lshl_add_u32 v52, v2, 3, v52
    v_bfe_u32 v2, v0, 3, 2
    v_lshl_add_u32 v52, v2, 5, v52
    v_add_u32 v52, s62, v52
    v_xor_b32 v53, 32, v52
    v_xor_b32 v54, 64, v52
    v_xor_b32 v55, 96, v52
    v_and_b32 v1, 15, v0
    v_lshrrev_b32 v2, 4, v0
    v_min_u32 v14, 5, v1
    v_mul_u32_u24 v14, 144, v14
    v_lshl_add_u32 v14, v2, 4, v14
    v_and_b32 v3, 3, v0
    v_bfe_u32 v1, v0, 2, 2
    v_add_u32 v15, 3, v3
    v_min_u32 v15, 5, v15
    v_cmp_eq_u32 vcc, 0, v3
    s_nop 1
    v_cndmask_b32 v15, v15, v1, vcc
    v_mul_u32_u24 v15, 144, v15
    v_lshl_add_u32 v15, v2, 4, v15
    s_and_b32 s62, s3, 3
    s_lshl_b32 s63, s62, 10
    v_and_b32 v2, 15, v0
    v_lshlrev_b32 v72, 8, v2
    v_and_b32 v1, 0x30, v0
    v_add3_u32 v72, v72, v1, s63
    v_lshl_add_u32 v73, v0, 4, s63
    v_lshlrev_b32 v74, 6, v1
    v_lshl_add_u32 v74, v2, 4, v74
    s_lshl_b32 s62, s62, 8
    v_add_u32 v75, s62, v1
    s_mul_i32 s90, s54, 5248
    s_add_u32 s90, s90, s62
    s_add_u32 s90, s90, 1900544
    s_mul_i32 s91, s101, 0x01010101
    v_mov_b32 v76, 0xff
    s_waitcnt vmcnt(0) lgkmcnt(0)
    ds_read_b64_tr_b16 v[16:17], v52 offset:0
    ds_read_b64_tr_b16 v[18:19], v52 offset:512
    ds_read_b64_tr_b16 v[20:21], v52 offset:4096
    ds_read_b64_tr_b16 v[22:23], v52 offset:4608
    ds_read_b64_tr_b16 v[24:25], v53 offset:0
    ds_read_b64_tr_b16 v[26:27], v53 offset:512
    ds_read_b64_tr_b16 v[28:29], v53 offset:4096
    ds_read_b64_tr_b16 v[30:31], v53 offset:4608
    ds_read_b64_tr_b16 v[32:33], v54 offset:0
    ds_read_b64_tr_b16 v[34:35], v54 offset:512
    ds_read_b64_tr_b16 v[36:37], v54 offset:4096
    ds_read_b64_tr_b16 v[38:39], v54 offset:4608
    ds_read_b64_tr_b16 v[40:41], v55 offset:0
    ds_read_b64_tr_b16 v[42:43], v55 offset:512
    ds_read_b64_tr_b16 v[44:45], v55 offset:4096
    ds_read_b64_tr_b16 v[46:47], v55 offset:4608
    ds_read_b128 v[4:7], v14 offset:12352
    ds_read_b128 v[8:11], v14 offset:12416
    s_waitcnt lgkmcnt(0)
    v_mfma_f32_16x16x32_bf16 v[48:51], v[16:19], v[4:7], 0
    v_mfma_f32_16x16x32_bf16 v[52:55], v[24:27], v[4:7], 0
    v_mfma_f32_16x16x32_bf16 v[56:59], v[32:35], v[4:7], 0
    v_mfma_f32_16x16x32_bf16 v[60:63], v[40:43], v[4:7], 0
    v_mfma_f32_16x16x32_bf16 v[48:51], v[20:23], v[8:11], v[48:51]
    v_mfma_f32_16x16x32_bf16 v[52:55], v[28:31], v[8:11], v[52:55]
    v_mfma_f32_16x16x32_bf16 v[56:59], v[36:39], v[8:11], v[56:59]
    v_mfma_f32_16x16x32_bf16 v[60:63], v[44:47], v[8:11], v[60:63]
    s_nop 4
    v_bfi_b32 v16, v76, s91, v48
    v_bfi_b32 v20, v76, s91, v52
    v_bfi_b32 v24, v76, s91, v56
    v_bfi_b32 v28, v76, s91, v60
    s_lshr_b32 s91, s91, 8
    v_bfi_b32 v17, v76, s91, v49
    v_bfi_b32 v21, v76, s91, v53
    v_bfi_b32 v25, v76, s91, v57
    v_bfi_b32 v29, v76, s91, v61
    s_lshr_b32 s91, s91, 8
    v_bfi_b32 v18, v76, s91, v50
    v_bfi_b32 v22, v76, s91, v54
    v_bfi_b32 v26, v76, s91, v58
    v_bfi_b32 v30, v76, s91, v62
    s_lshr_b32 s91, s91, 8
    v_bfi_b32 v19, v76, s91, v51
    v_bfi_b32 v23, v76, s91, v55
    v_bfi_b32 v27, v76, s91, v59
    v_bfi_b32 v31, v76, s91, v63
    s_lshr_b32 s91, s91, 8
    s_and_b32 exec_lo, s60, 0xf000f
    s_and_b32 exec_hi, s60, 0xf000f
    ds_write_b128 v72, v[16:19] offset:0
    ds_write_b128 v72, v[20:23] offset:64
    ds_write_b128 v72, v[24:27] offset:128
    ds_write_b128 v72, v[28:31] offset:192
    s_and_b32 exec_lo, s60, 0x100010
    s_and_b32 exec_hi, s60, 0x100010
    ds_write_b128 v75, v[48:51] offset:17488
    ds_write_b128 v75, v[52:55] offset:17552
    ds_write_b128 v75, v[56:59] offset:17616
    ds_write_b128 v75, v[60:63] offset:17680
    s_mov_b64 exec, s[60:61]
    s_waitcnt lgkmcnt(0)
    ds_read_b128 v[16:19], v73 offset:0
    s_waitcnt lgkmcnt(0)
    buffer_store_dwordx4 v[16:19], v74, s[16:19], s90 offen sc1
    s_branch L_noq_14
L_noq_13:
    s_waitcnt vmcnt(0)
    v_mov_b32 v4, 16688
    v_mov_b32 v5, 1
    s_mov_b64 exec, 1
    ds_add_u32 v4, v5 offset:4
    s_mov_b64 exec, -1
    v_mov_b32 v5, 16688
L_sp_17:
    ds_read_b32 v4, v5 offset:4
    s_waitcnt lgkmcnt(0)
    v_cmp_gt_u32 vcc, 4, v4
    s_cbranch_vccnz L_spr_18
L_noq_14:
    v_lshrrev_b32 v1, 4, v0
    v_mul_u32_u24 v3, 1280, v1
    v_and_b32 v2, 7, v0
    v_lshl_add_u32 v3, v2, 1, v3
    s_lshl_b32 s62, s52, 7
    s_lshl_b32 s63, s3, 4
    s_add_u32 s62, s62, s63
    v_add_u32 v3, s62, v3
    v_mov_b32 v80, 0
    ds_read_u16_d16_hi v80, v3 offset:18512
    s_waitcnt lgkmcnt(0)
    v_mov_b32 v4, 16688
    v_mov_b32 v5, 1
    s_mov_b64 exec, 1
    ds_add_u32 v4, v5 offset:4
    s_mov_b64 exec, -1
    s_bitcmp1_b32 s57, 4
    s_cbranch_scc0 L_role_19
    v_mov_b32 v64, -1
    v_mov_b32 v65, -1
    v_mov_b32 v66, -1
    v_mov_b32 v67, -1
    v_lshlrev_b32 v10, 4, v0
    s_cmp_ge_u32 s5, 30
    s_cbranch_scc1 L_nocl_20
    s_lshl_b32 s62, s55, 10
    s_add_u32 s88, s62, 229376
    s_add_u32 s89, s62, 475136
    s_add_u32 s90, s62, 720896
    s_add_u32 s91, s62, 966656
    buffer_store_dwordx4 v[64:67], v10, s[16:19], s88 offen sc1
    buffer_store_dwordx4 v[64:67], v10, s[16:19], s89 offen sc1
    buffer_store_dwordx4 v[64:67], v10, s[16:19], s90 offen sc1
    buffer_store_dwordx4 v[64:67], v10, s[16:19], s91 offen sc1
L_nocl_20:
    s_mov_b64 exec, -1
    s_getreg_b32 s99, hwreg(HW_REG_XCC_ID, 0, 4)
    v_mov_b32 v6, s101
    v_mov_b32 v7, s99
    v_mov_b32 v8, s101
    v_mov_b32 v9, s99
    v_mov_b32 v4, 16688
    v_mov_b32 v5, 1
    s_lshl_b32 s88, s54, 7
    s_add_u32 s88, s88, 3244032
    s_waitcnt vmcnt(0)
    s_mov_b64 exec, 0xff
    buffer_store_dwordx4 v[6:9], v10, s[16:19], s88 offen sc1
    s_mov_b64 exec, -1
L_role_19:
    s_setprio 0
    s_mov_b32 s62, 0
    buffer_load_dwordx4 a[0:3], v84, s[8:11], s62 offen offset:0 nt
    buffer_load_dwordx4 a[4:7], v84, s[8:11], s62 offen offset:128 nt
    buffer_load_dwordx4 a[16:19], v84, s[8:11], s62 offen offset:256 nt
    s_mov_b32 s62, 3072
    buffer_load_dwordx4 a[8:11], v84, s[8:11], s62 offen offset:0 nt
    buffer_load_dwordx4 a[12:15], v84, s[8:11], s62 offen offset:128 nt
    buffer_load_dwordx4 a[20:23], v84, s[8:11], s62 offen offset:256 nt
    s_mov_b32 s62, 6144
    buffer_load_dwordx4 a[24:27], v84, s[8:11], s62 offen offset:0 nt
    buffer_load_dwordx4 a[28:31], v84, s[8:11], s62 offen offset:128 nt
    buffer_load_dwordx4 a[40:43], v84, s[8:11], s62 offen offset:256 nt
    s_mov_b32 s62, 9216
    buffer_load_dwordx4 a[32:35], v84, s[8:11], s62 offen offset:0 nt
    buffer_load_dwordx4 a[36:39], v84, s[8:11], s62 offen offset:128 nt
    buffer_load_dwordx4 a[44:47], v84, s[8:11], s62 offen offset:256 nt
    s_mov_b32 s62, 12288
    buffer_load_dwordx4 a[48:51], v84, s[8:11], s62 offen offset:0 nt
    buffer_load_dwordx4 a[52:55], v84, s[8:11], s62 offen offset:128 nt
    buffer_load_dwordx4 a[64:67], v84, s[8:11], s62 offen offset:256 nt
    s_mov_b32 s62, 15360
    buffer_load_dwordx4 a[56:59], v84, s[8:11], s62 offen offset:0 nt
    buffer_load_dwordx4 a[60:63], v84, s[8:11], s62 offen offset:128 nt
    buffer_load_dwordx4 a[68:71], v84, s[8:11], s62 offen offset:256 nt
    s_mov_b32 s62, 18432
    buffer_load_dwordx4 a[72:75], v84, s[8:11], s62 offen offset:0 nt
    buffer_load_dwordx4 a[76:79], v84, s[8:11], s62 offen offset:128 nt
    buffer_load_dwordx4 a[88:91], v84, s[8:11], s62 offen offset:256 nt
    s_mov_b32 s62, 21504
    buffer_load_dwordx4 a[80:83], v84, s[8:11], s62 offen offset:0 nt
    buffer_load_dwordx4 a[84:87], v84, s[8:11], s62 offen offset:128 nt
    buffer_load_dwordx4 a[92:95], v84, s[8:11], s62 offen offset:256 nt
    s_mul_i32 s63, s3, 6144
    s_add_u32 m0, s63, 113792
    s_mov_b32 s62, 0
    buffer_load_dwordx4 v85, s[12:15], s62 offen nt lds
    s_add_u32 m0, s63, 115840
    s_mov_b32 s62, 128
    buffer_load_dwordx4 v85, s[12:15], s62 offen nt lds
    s_add_u32 m0, s63, 117888
    s_mov_b32 s62, 256
    buffer_load_dwordx4 v85, s[12:15], s62 offen nt lds
    s_add_u32 m0, s63, 114816
    s_mov_b32 s62, 6144
    buffer_load_dwordx4 v85, s[12:15], s62 offen nt lds
    s_add_u32 m0, s63, 116864
    s_mov_b32 s62, 6272
    buffer_load_dwordx4 v85, s[12:15], s62 offen nt lds
    s_add_u32 m0, s63, 118912
    s_mov_b32 s62, 6400
    buffer_load_dwordx4 v85, s[12:15], s62 offen nt lds
    s_mov_b32 s62, 1536
    buffer_load_dwordx4 v[88:91], v85, s[12:15], s62 offen offset:0 nt
    buffer_load_dwordx4 v[96:99], v85, s[12:15], s62 offen offset:128 nt
    buffer_load_dwordx4 v[104:107], v85, s[12:15], s62 offen offset:256 nt
    s_mov_b32 s62, 7680
    buffer_load_dwordx4 v[92:95], v85, s[12:15], s62 offen offset:0 nt
    buffer_load_dwordx4 v[100:103], v85, s[12:15], s62 offen offset:128 nt
    buffer_load_dwordx4 v[108:111], v85, s[12:15], s62 offen offset:256 nt
    s_mov_b32 s62, 12288
    buffer_load_dwordx4 v[112:115], v85, s[12:15], s62 offen offset:0 nt
    buffer_load_dwordx4 v[120:123], v85, s[12:15], s62 offen offset:128 nt
    buffer_load_dwordx4 v[128:131], v85, s[12:15], s62 offen offset:256 nt
    s_mov_b32 s62, 18432
    buffer_load_dwordx4 v[116:119], v85, s[12:15], s62 offen offset:0 nt
    buffer_load_dwordx4 v[124:127], v85, s[12:15], s62 offen offset:128 nt
    buffer_load_dwordx4 v[132:135], v85, s[12:15], s62 offen offset:256 nt
    s_mov_b32 s62, 13824
    buffer_load_dwordx4 v[136:139], v85, s[12:15], s62 offen offset:0 nt
    buffer_load_dwordx4 v[144:147], v85, s[12:15], s62 offen offset:128 nt
    buffer_load_dwordx4 v[152:155], v85, s[12:15], s62 offen offset:256 nt
    s_mov_b32 s62, 19968
    buffer_load_dwordx4 v[140:143], v85, s[12:15], s62 offen offset:0 nt
    buffer_load_dwordx4 v[148:151], v85, s[12:15], s62 offen offset:128 nt
    buffer_load_dwordx4 v[156:159], v85, s[12:15], s62 offen offset:256 nt
    v_mov_b32 v4, 16688
    v_mov_b32 v5, 1
    s_mov_b64 exec, 1
    ds_add_u32 v4, v5 offset:16
    s_mov_b64 exec, -1
    v_lshrrev_b32 v1, 4, v0
    v_and_b32 v2, 3, v0
    v_lshlrev_b32 v2, 4, v2
    v_lshl_add_u32 v76, v1, 6, v2
    v_and_b32 v3, 0x40, v76
    v_add3_u32 v77, v3, v2, 64
    v_add_u32 v77, 192, v77
    v_bfe_u32 v2, v0, 2, 2
    v_mov_b32 v3, 384
    v_cmp_eq_u32 vcc, 0, v2
    s_nop 1
    v_cndmask_b32 v72, v3, v76, vcc
    v_cmp_eq_u32 vcc, 1, v2
    s_nop 1
    v_cndmask_b32 v73, v3, v76, vcc
    v_cmp_eq_u32 vcc, 2, v2
    s_nop 1
    v_cndmask_b32 v74, v3, v76, vcc
    v_cmp_eq_u32 vcc, 3, v2
    s_nop 1
    v_cndmask_b32 v75, v3, v76, vcc
    v_lshrrev_b32 v1, 5, v0
    v_cmp_eq_u32 vcc, v1, v2
    s_nop 1
    v_cndmask_b32 v76, v3, v77, vcc
    v_add_u32 v1, 2, v1
    v_cmp_eq_u32 vcc, v1, v2
    s_nop 1
    v_cndmask_b32 v77, v3, v77, vcc
    v_and_b32 v1, 1, v0
    v_mul_u32_u24 v78, 0xaaaa, v1
    v_add_u32 v78, 0x4444, v78
    v_and_b32 v1, 3, v0
    v_xor_b32 v2, 1, v1
    v_lshl_add_u32 v79, v2, 2, v1
    v_mul_u32_u24 v79, 0x1111, v79
    v_bfe_u32 v1, v0, 2, 1
    v_mul_u32_u24 v85, 0xffff, v1
    v_sub_u32 v84, 0xffff, v85
    s_mul_i32 s62, s3, 6144
    s_add_u32 s62, s62, 113792
    v_lshl_add_u32 v86, v0, 4, s62
    v_and_b32 v1, 7, v0
    v_lshlrev_b32 v1, 5, v1
    v_bfe_u32 v2, v0, 4, 1
    v_lshl_add_u32 v1, v2, 4, v1
    v_lshrrev_b32 v2, 5, v0
    v_mul_u32_u24 v2, 768, v2
    s_mul_i32 s62, s3, 1536
    v_add3_u32 v87, v1, v2, s62
    v_mov_b32 v28, 0
    v_mov_b32 v29, 0
    v_mov_b32 v30, 0
    v_mov_b32 v31, 0
    v_mov_b32 v32, 0
    v_mov_b32 v33, 0
    v_mov_b32 v34, 0
    v_mov_b32 v35, 0
    v_mov_b32 v36, 0
    v_mov_b32 v37, 0
    v_mov_b32 v38, 0
    v_mov_b32 v39, 0
    v_mov_b32 v40, 0
    v_mov_b32 v41, 0
    v_mov_b32 v42, 0
    v_mov_b32 v43, 0
    v_mov_b32 v44, 0
    v_mov_b32 v45, 0
    v_mov_b32 v46, 0
    v_mov_b32 v47, 0
    s_mov_b32 s47, s101
    s_mov_b32 s40, 81920
    s_mov_b32 s41, 163840
    s_mov_b32 s42, 10752
    s_mov_b32 s43, 20992
    v_mov_b32 v5, 16688
L_sp_22:
    ds_read_b32 v4, v5 offset:0
    s_waitcnt lgkmcnt(0)
    v_cmp_gt_u32 vcc, 1, v4
    s_cbranch_vccnz L_spr_23
    s_branch L_attn
    .p2align 8
L_attn_bar:
    s_waitcnt vmcnt(0) lgkmcnt(0)
    s_barrier
L_attn:
    ds_read_b128 v[4:7], v72 offset:16288
    ds_read_b128 v[8:11], v73 offset:16288
    ds_read_b128 v[20:23], v76 offset:16288
    ds_read_b128 v[12:15], v74 offset:16288
    ds_read_b128 v[16:19], v75 offset:16288
    ds_read_b128 v[24:27], v77 offset:16288
    s_mov_b32 s90, 0
    s_mul_i32 s63, s54, 896
    s_add_u32 s90, s90, s63
    s_and_b32 s88, s3, 3
    s_lshl_b32 s88, s88, 8
    s_add_u32 s89, s88, s90
    s_mov_b32 s62, 0xaaaaaaaa
    s_mov_b32 s63, 0xaaaaaaaa
    s_waitcnt vmcnt(24)
    s_waitcnt lgkmcnt(5)
    v_smfmac_f32_16x16x64_bf16 v[28:31], v[4:7], a[0:7], v78
    v_smfmac_f32_16x16x64_bf16 v[32:35], v[4:7], a[48:55], v78
    s_waitcnt lgkmcnt(4)
    v_smfmac_f32_16x16x64_bf16 v[28:31], v[8:11], a[8:15], v78
    v_smfmac_f32_16x16x64_bf16 v[32:35], v[8:11], a[56:63], v78
    s_waitcnt lgkmcnt(3)
    v_smfmac_f32_16x16x64_bf16 v[28:31], v[20:23], a[16:23], v78
    v_smfmac_f32_16x16x64_bf16 v[32:35], v[20:23], a[64:71], v78
    s_waitcnt lgkmcnt(2)
    v_smfmac_f32_16x16x64_bf16 v[28:31], v[12:15], a[24:31], v78
    v_smfmac_f32_16x16x64_bf16 v[32:35], v[12:15], a[72:79], v78
    s_waitcnt lgkmcnt(1)
    v_smfmac_f32_16x16x64_bf16 v[28:31], v[16:19], a[32:39], v78
    v_smfmac_f32_16x16x64_bf16 v[32:35], v[16:19], a[80:87], v78
    s_waitcnt lgkmcnt(0)
    v_smfmac_f32_16x16x64_bf16 v[28:31], v[24:27], a[40:47], v78
    v_smfmac_f32_16x16x64_bf16 v[32:35], v[24:27], a[88:95], v78
    s_waitcnt vmcnt(18)
    ds_read_b128 v[48:51], v86 offset:0
    ds_read_b128 v[52:55], v86 offset:1024
    ds_read_b128 v[56:59], v86 offset:2048
    ds_read_b128 v[60:63], v86 offset:3072
    ds_read_b128 v[64:67], v86 offset:4096
    ds_read_b128 v[68:71], v86 offset:5120
    v_lshrrev_b32 v1, 4, v0
    v_add_f32 v28, v28, v29
    v_add_f32 v32, v32, v33
    v_add_f32 v30, v30, v31
    v_add_f32 v34, v34, v35
    v_cndmask_b32 v28, v28, v30, s[62:63]
    v_cndmask_b32 v32, v32, v34, s[62:63]
    v_mov_b32 v19, 12288
    v_add_f32_dpp v28, v28, v28 quad_perm:[1,0,3,2] row_mask:0xf bank_mask:0xf
    v_add_f32_dpp v32, v32, v32 quad_perm:[1,0,3,2] row_mask:0xf bank_mask:0xf
    v_cvt_pk_bf16_f32 v28, 0, v28
    v_cvt_pk_bf16_f32 v32, 0, v32
    v_mul_f32 v28, s94, v28
    v_mul_f32 v32, s94, v32
    v_cvt_pk_bf16_f32 v28, 0, v28
    v_cvt_pk_bf16_f32 v32, 0, v32
    v_mul_f32 v28, s93, v28
    v_mul_f32 v32, s93, v32
    v_max_f32 v29, v28, v32
    v_and_b32 v2, 15, v0
    v_mul_u32_u24 v12, 3072, v1
    v_max_f32_dpp v29, v29, v29 quad_perm:[2,3,0,1] row_mask:0xf bank_mask:0xf
    v_lshlrev_b32 v13, 3, v1
    v_lshl_add_u32 v12, v2, 4, v12
    v_max_f32_dpp v29, v29, v29 row_half_mirror row_mask:0xf bank_mask:0xf
    v_lshlrev_b32 v15, 4, v2
    v_add_u32 v12, s88, v12
    v_max_f32_dpp v29, v29, v29 row_mirror row_mask:0xf bank_mask:0xf
    v_lshl_add_u32 v15, v1, 2, v15
    v_mov_b32 v14, 0
    v_max_f32_dpp v29, v29, v29 row_bcast:15 row_mask:0xa bank_mask:0xf
    v_add_u32 v15, s89, v15
    v_lshl_add_u32 v16, v0, 4, s90
    v_max_f32_dpp v29, v29, v29 row_bcast:31 row_mask:0xc bank_mask:0xf
    v_and_b32 v17, 7, v0
    v_readlane_b32 s92, v29, 63
    v_lshlrev_b32 v17, 2, v17
    s_lshl_b32 s91, s3, 2
    v_add_u32 v35, s91, v19
    v_subrev_f32 v28, s92, v28
    v_subrev_f32 v32, s92, v32
    v_exp_f32 v28, v28
    v_exp_f32 v32, v32
    v_cvt_pk_bf16_f32 v30, v28, v28
    v_cvt_pk_bf16_f32 v31, v32, v32
    v_mov_b32 v34, s92
    v_and_b32_dpp v4, v30, v84 row_newbcast:0 row_mask:0xf bank_mask:0x3
    v_and_b32_dpp v5, v30, v85 row_newbcast:0 row_mask:0xf bank_mask:0x3
    v_and_b32_dpp v6, v30, v84 row_newbcast:4 row_mask:0xf bank_mask:0x3
    v_and_b32_dpp v7, v30, v85 row_newbcast:4 row_mask:0xf bank_mask:0x3
    v_and_b32_dpp v4, v30, v84 row_newbcast:2 row_mask:0xf bank_mask:0xc
    v_and_b32_dpp v5, v30, v85 row_newbcast:2 row_mask:0xf bank_mask:0xc
    v_and_b32_dpp v6, v30, v84 row_newbcast:6 row_mask:0xf bank_mask:0xc
    v_and_b32_dpp v7, v30, v85 row_newbcast:6 row_mask:0xf bank_mask:0xc
    s_waitcnt lgkmcnt(0)
    s_nop 0
    v_smfmac_f32_16x16x64_bf16 v[36:39], v[4:7], v[48:55], v79
    v_and_b32_dpp v8, v30, v84 row_newbcast:8 row_mask:0xf bank_mask:0x3
    v_and_b32_dpp v9, v30, v85 row_newbcast:8 row_mask:0xf bank_mask:0x3
    v_and_b32_dpp v10, v30, v84 row_newbcast:12 row_mask:0xf bank_mask:0x3
    v_add_f32 v33, v28, v32
    v_smfmac_f32_16x16x64_bf16 v[40:43], v[4:7], v[56:63], v79
    v_and_b32_dpp v11, v30, v85 row_newbcast:12 row_mask:0xf bank_mask:0x3
    v_and_b32_dpp v8, v30, v84 row_newbcast:10 row_mask:0xf bank_mask:0xc
    v_and_b32_dpp v9, v30, v85 row_newbcast:10 row_mask:0xf bank_mask:0xc
    v_smfmac_f32_16x16x64_bf16 v[44:47], v[4:7], v[64:71], v79
    v_and_b32_dpp v10, v30, v84 row_newbcast:14 row_mask:0xf bank_mask:0xc
    v_and_b32_dpp v11, v30, v85 row_newbcast:14 row_mask:0xf bank_mask:0xc
    v_add_f32_dpp v33, v33, v33 quad_perm:[2,3,0,1] row_mask:0xf bank_mask:0xf
    s_waitcnt vmcnt(12)
    v_smfmac_f32_16x16x64_bf16 v[36:39], v[8:11], v[88:95], v79
    v_and_b32_dpp v4, v31, v84 row_newbcast:0 row_mask:0xf bank_mask:0x3
    v_and_b32_dpp v5, v31, v85 row_newbcast:0 row_mask:0xf bank_mask:0x3
    v_and_b32_dpp v6, v31, v84 row_newbcast:4 row_mask:0xf bank_mask:0x3
    v_add_f32_dpp v33, v33, v33 row_half_mirror row_mask:0xf bank_mask:0xf
    v_smfmac_f32_16x16x64_bf16 v[40:43], v[8:11], v[96:103], v79
    v_and_b32_dpp v7, v31, v85 row_newbcast:4 row_mask:0xf bank_mask:0x3
    v_and_b32_dpp v4, v31, v84 row_newbcast:2 row_mask:0xf bank_mask:0xc
    v_and_b32_dpp v5, v31, v85 row_newbcast:2 row_mask:0xf bank_mask:0xc
    v_smfmac_f32_16x16x64_bf16 v[44:47], v[8:11], v[104:111], v79
    v_and_b32_dpp v6, v31, v84 row_newbcast:6 row_mask:0xf bank_mask:0xc
    v_and_b32_dpp v7, v31, v85 row_newbcast:6 row_mask:0xf bank_mask:0xc
    v_add_f32_dpp v33, v33, v33 row_mirror row_mask:0xf bank_mask:0xf
    s_waitcnt vmcnt(6)
    v_smfmac_f32_16x16x64_bf16 v[36:39], v[4:7], v[112:119], v79
    v_and_b32_dpp v8, v31, v84 row_newbcast:8 row_mask:0xf bank_mask:0x3
    v_and_b32_dpp v9, v31, v85 row_newbcast:8 row_mask:0xf bank_mask:0x3
    v_and_b32_dpp v10, v31, v84 row_newbcast:12 row_mask:0xf bank_mask:0x3
    v_add_f32_dpp v33, v33, v33 row_bcast:15 row_mask:0xa bank_mask:0xf
    v_smfmac_f32_16x16x64_bf16 v[40:43], v[4:7], v[120:127], v79
    v_and_b32_dpp v11, v31, v85 row_newbcast:12 row_mask:0xf bank_mask:0x3
    v_and_b32_dpp v8, v31, v84 row_newbcast:10 row_mask:0xf bank_mask:0xc
    v_and_b32_dpp v9, v31, v85 row_newbcast:10 row_mask:0xf bank_mask:0xc
    v_smfmac_f32_16x16x64_bf16 v[44:47], v[4:7], v[128:135], v79
    v_and_b32_dpp v10, v31, v84 row_newbcast:14 row_mask:0xf bank_mask:0xc
    v_and_b32_dpp v11, v31, v85 row_newbcast:14 row_mask:0xf bank_mask:0xc
    v_add_f32_dpp v33, v33, v33 row_bcast:31 row_mask:0xc bank_mask:0xf
    s_waitcnt vmcnt(0)
    v_smfmac_f32_16x16x64_bf16 v[36:39], v[8:11], v[136:143], v79
    v_smfmac_f32_16x16x64_bf16 v[40:43], v[8:11], v[144:151], v79
    v_smfmac_f32_16x16x64_bf16 v[44:47], v[8:11], v[152:159], v79
    s_and_b32 exec_lo, s60, 0x0
    s_and_b32 exec_hi, s60, 0x80000000
    ds_write2_b32 v35, v34, v33 offset0:0 offset1:8
    s_and_b32 exec_lo, s60, 0xff00ff
    s_and_b32 exec_hi, s60, 0xff00ff00
    s_nop 0
    ds_write_b128 v87, v[36:39] offset:0
    ds_write_b128 v87, v[40:43] offset:256
    ds_write_b128 v87, v[44:47] offset:512
    s_mov_b64 exec, s[60:61]
    s_bitcmp1_b32 s57, 0
    s_cbranch_scc0 L_role_25
    s_cmp_eq_u32 s6, 0
    s_cbranch_scc0 L_p0_26
    s_cmp_eq_u32 s3, 0
    s_cbranch_scc0 L_nochk_28
    v_mov_b32 v1, 16688
    v_mov_b32 v2, s101
    v_lshlrev_b32 v3, 9, v0
    s_getreg_b32 s99, hwreg(HW_REG_XCC_ID, 0, 4)
    s_mov_b32 s62, 3244032
L_chk_29:
    buffer_load_dwordx2 v[4:5], v3, s[16:19], s62 offen offset:0 sc1
    buffer_load_dwordx2 v[6:7], v3, s[16:19], s62 offen offset:128 sc1
    buffer_load_dwordx2 v[8:9], v3, s[16:19], s62 offen offset:256 sc1
    buffer_load_dwordx2 v[10:11], v3, s[16:19], s62 offen offset:384 sc1
    s_waitcnt vmcnt(0)
    v_xor_b32 v4, v4, v2
    v_xor_b32 v6, v6, v2
    v_xor_b32 v8, v8, v2
    v_xor_b32 v10, v10, v2
    v_or3_b32 v4, v4, v6, v8
    v_or_b32 v4, v4, v10
    v_cmp_ne_u32 vcc, 0, v4
    s_cbranch_vccnz L_chkr_30
    v_xor_b32 v5, s99, v5
    v_xor_b32 v7, s99, v7
    v_xor_b32 v9, s99, v9
    v_xor_b32 v11, s99, v11
    v_or3_b32 v5, v5, v7, v9
    v_or_b32 v5, v5, v11
    v_cmp_eq_u32 vcc, 0, v5
    s_lshl_b32 s63, s4, 3
    s_lshr_b64 s[62:63], vcc, s63
    s_and_b32 s62, s62, 0xff
    s_cmp_eq_u32 s62, 0xff
    s_cselect_b32 s62, 1, 0
    v_mov_b32 v4, s62
    ds_write_b32 v1, v4 offset:12
    s_cmp_eq_u32 s2, 0
    s_cbranch_scc0 L_nochk_28
    v_mov_b32 v58, 0
    v_add_u32 v59, 1, v2
    s_mov_b32 s62, 3276800
    s_mov_b64 exec, 1
    buffer_store_dword v59, v58, s[16:19], s62 offen sc1
    s_mov_b64 exec, -1
L_nochk_28:
    s_cmp_eq_u32 s3, 1
    s_cbranch_scc0 L_npw_32
    v_lshlrev_b32 v1, 4, v0
    s_mul_i32 s62, s54, 5248
    s_add_u32 s62, s62, 1904768
    buffer_load_dwordx4 v[60:63], v1, s[16:19], s62 offen sc1
    s_mov_b32 exec_hi, 0xffffff
    buffer_load_dwordx4 v[60:63], v1, s[16:19], s90 offen sc1
    s_mov_b64 exec, -1
L_npw_32:
    s_cmp_ge_u32 s5, 30
    s_cbranch_scc1 L_ntq_33
    v_lshrrev_b32 v1, 3, v0
    v_mul_u32_u24 v6, 1280, v1
    v_bfe_u32 v1, v0, 4, 1
    v_bfe_u32 v2, v0, 1, 2
    v_xor_b32 v1, v1, v2
    v_lshl_add_u32 v6, v1, 5, v6
    v_and_b32 v1, 1, v0
    v_lshl_add_u32 v6, v1, 4, v6
    v_xor_b32 v7, 64, v6
    s_mul_i32 s63, s3, 8
    s_add_u32 s63, s63, 0
    s_mul_i32 s88, s63, 10240
    s_lshl_b32 s63, s63, 10
    v_mov_b32 v5, 16688
L_sp_34:
    ds_read_b32 v4, v5 offset:16
    s_waitcnt lgkmcnt(0)
    v_cmp_gt_u32 vcc, 4, v4
    s_cbranch_vccnz L_spr_35
    s_add_u32 m0, s63, 48256
    s_add_u32 s62, s88, 0
    buffer_load_dwordx4 v6, s[24:27], s62 offen nt lds
    s_add_u32 m0, s63, 49280
    s_add_u32 s62, s88, 10240
    buffer_load_dwordx4 v7, s[24:27], s62 offen nt lds
    s_add_u32 m0, s63, 50304
    s_add_u32 s62, s88, 20480
    buffer_load_dwordx4 v6, s[24:27], s62 offen nt lds
    s_add_u32 m0, s63, 51328
    s_add_u32 s62, s88, 30720
    buffer_load_dwordx4 v7, s[24:27], s62 offen nt lds
    s_add_u32 m0, s63, 52352
    s_add_u32 s62, s88, 40960
    buffer_load_dwordx4 v6, s[24:27], s62 offen nt lds
    s_add_u32 m0, s63, 53376
    s_add_u32 s62, s88, 51200
    buffer_load_dwordx4 v7, s[24:27], s62 offen nt lds
    s_add_u32 m0, s63, 54400
    s_add_u32 s62, s88, 61440
    buffer_load_dwordx4 v6, s[24:27], s62 offen nt lds
    s_add_u32 m0, s63, 55424
    s_add_u32 s62, s88, 71680
    buffer_load_dwordx4 v7, s[24:27], s62 offen nt lds
L_ntq_33:
L_p0_26:
    s_cmp_eq_u32 s5, 30
    s_cbranch_scc0 L_wb_36
    s_lshl_b32 s62, s3, 1
    s_or_b32 s62, s62, s6
    s_cmp_eq_u32 s62, 1
    s_cbranch_scc0 L_wb_36
    buffer_wbl2 sc1
L_wb_36:
L_role_25:
    s_waitcnt lgkmcnt(0)
    s_barrier
    s_bitcmp1_b32 s57, 1
    s_cbranch_scc0 L_role_38
    s_setprio 1
    ds_read_b32 v47, v14 offset:16700
    s_bitcmp1_b32 s57, 2
    s_cbranch_scc0 L_role_39
    ds_read_b128 v[20:23], v14 offset:12288
    ds_read_b128 v[24:27], v14 offset:12304
    ds_read_b64 v[18:19], v13 offset:12288
    ds_read_b128 v[48:51], v12 offset:0
    ds_read_b128 v[52:55], v12 offset:768
    ds_read_b128 v[56:59], v12 offset:1536
    ds_read_b128 v[60:63], v12 offset:2304
    v_subrev_u32 v28, 16, v0
    v_ashrrev_i32 v28, 31, v28
    v_and_b32 v28, 0xff, v28
    s_mul_i32 s62, s47, 0x01010101
    v_bfe_u32 v29, v0, 0, 2
    v_lshlrev_b32 v29, 3, v29
    v_lshrrev_b32 v29, v29, s62
    s_waitcnt lgkmcnt(5)
    v_max3_f32 v20, v20, v21, v22
    v_max3_f32 v24, v24, v25, v26
    v_readfirstlane_b32 s56, v47
    v_max3_f32 v20, v20, v23, v27
    v_max_f32 v20, v20, v24
    s_waitcnt lgkmcnt(2)
    v_sub_f32 v18, v18, v20
    v_sub_f32 v19, v19, v20
    v_add_f32 v48, v48, v52
    v_exp_f32 v18, v18
    v_add_f32 v49, v49, v53
    v_exp_f32 v19, v19
    v_add_f32 v50, v50, v54
    v_add_f32 v51, v51, v55
    s_waitcnt lgkmcnt(0)
    v_add_f32 v56, v56, v60
    v_mul_f32 v48, v18, v48
    v_add_f32 v57, v57, v61
    v_mul_f32 v49, v18, v49
    v_add_f32 v58, v58, v62
    v_mul_f32 v50, v18, v50
    v_add_f32 v59, v59, v63
    v_mul_f32 v51, v18, v51
    v_fmac_f32 v48, v19, v56
    v_fmac_f32 v50, v19, v58
    v_fmac_f32 v49, v19, v57
    v_fmac_f32 v51, v19, v59
    v_permlane32_swap_b32 v48, v50
    s_nop 0
    v_permlane32_swap_b32 v49, v51
    v_add_f32 v48, v48, v50
    v_add_f32 v49, v49, v51
    s_nop 1
    v_permlane16_swap_b32 v48, v49
    v_add_f32 v48, v48, v49
    v_bfi_b32 v48, v28, v29, v48
    s_cmp_eq_u32 s56, 0
    s_cbranch_scc1 L_st_40
    buffer_store_dword v48, v15, s[16:19], 0 offen
L_st_41:
L_role_39:
    s_bitcmp1_b32 s57, 3
    s_cbranch_scc0 L_role_42
    ds_read_b32 v4, v17 offset:12288
    ds_read_b32 v5, v17 offset:12320
    v_mov_b32 v8, s47
    s_waitcnt lgkmcnt(1)
    v_max_f32_dpp v6, v4, v4 quad_perm:[1,0,3,2] row_mask:0xf bank_mask:0xf
    v_readfirstlane_b32 s56, v47
    s_nop 0
    v_max_f32_dpp v6, v6, v6 quad_perm:[2,3,0,1] row_mask:0xf bank_mask:0xf
    s_nop 1
    v_max_f32_dpp v6, v6, v6 row_half_mirror row_mask:0xf bank_mask:0xf
    v_sub_f32 v4, v4, v6
    v_exp_f32 v4, v4
    s_waitcnt lgkmcnt(0)
    v_mul_f32 v7, v4, v5
    s_nop 1
    v_add_f32_dpp v7, v7, v7 quad_perm:[1,0,3,2] row_mask:0xf bank_mask:0xf
    s_nop 1
    v_add_f32_dpp v7, v7, v7 quad_perm:[2,3,0,1] row_mask:0xf bank_mask:0xf
    s_nop 1
    v_add_f32_dpp v7, v7, v7 row_half_mirror row_mask:0xf bank_mask:0xf
    s_and_b32 exec_lo, s60, 0xff
    s_and_b32 exec_hi, s60, 0x0
    s_cmp_eq_u32 s56, 0
    s_cbranch_scc1 L_st_43
    buffer_store_dwordx4 v[6:9], v16, s[16:19], 0 offen offset:768
L_st_44:
    s_mov_b64 exec, s[60:61]
    s_cmp_eq_u32 s6, 0
    s_cbranch_scc0 L_p0_45
    s_cmp_ge_u32 s5, 30
    s_cbranch_scc1 L_ncs_46
    v_lshlrev_b32 v1, 4, v0
    ds_read_b128 v[12:15], v1 offset:17488
    s_mul_i32 s62, s54, 5248
    s_add_u32 s62, s62, 1904768
    s_waitcnt lgkmcnt(0)
    s_mov_b32 s88, s62
    s_mul_i32 s62, s47, 0x01010101
    v_bfe_u32 v2, v0, 0, 2
    v_lshlrev_b32 v2, 3, v2
    v_lshrrev_b32 v2, v2, s62
    s_mov_b32 s62, s88
    v_mov_b32_sdwa v12, v2 dst_sel:BYTE_0 dst_unused:UNUSED_PRESERVE src0_sel:BYTE_0
    s_cmp_eq_u32 s56, 0
    s_cbranch_scc1 L_st_47
    buffer_store_dwordx4 v[12:15], v1, s[16:19], s62 offen
L_st_48:
L_ncs_46:
L_p0_45:
L_role_42:
    s_setprio 0
L_role_38:
    s_cmp_ge_u32 s5, 30
    s_cbranch_scc1 L_idle
    s_bitcmp1_b32 s57, 0
    s_cbranch_scc0 L_role_49
    s_mov_b32 s89, 0
    s_lshl_b32 s62, s53, 2
    s_add_u32 s62, s62, s3
    s_mul_i32 s63, s62, 86
    s_lshr_b32 s63, s63, 8
    s_mul_i32 s88, s63, 3
    s_sub_u32 s88, s62, s88
    s_lshl_b32 s63, s63, 3
    s_lshl_b32 s62, s4, 5
    s_add_u32 s63, s63, s62
    s_mul_i32 s63, s63, 896
    s_add_u32 s63, s63, s89
    v_lshrrev_b32 v1, 4, v0
    v_and_b32 v2, 15, v0
    v_mul_u32_u24 v72, 1792, v1
    v_add_u32 v72, s63, v72
    s_lshl_b32 s88, s88, 8
    v_lshl_add_u32 v73, v2, 4, v72
    v_add_u32 v73, s88, v73
    s_lshl_b32 s62, s3, 7
    v_mul_u32_u24 v74, 576, v1
    v_lshl_add_u32 v74, v2, 3, v74
    v_add_u32 v74, s62, v74
    v_mov_b32 v1, 0
    ds_read_b32 v47, v1 offset:16700
    s_mov_b32 s62, 48256
    v_lshrrev_b32 v1, 4, v0
    v_bfe_u32 v2, v0, 2, 2
    v_lshl_add_u32 v75, v1, 3, v2
    v_lshlrev_b32 v75, 7, v75
    v_and_b32 v2, 3, v0
    v_lshl_add_u32 v75, v2, 3, v75
    v_bfe_u32 v2, v0, 3, 2
    v_lshl_add_u32 v75, v2, 5, v75
    v_add_u32 v75, s62, v75
    s_lshl_b32 s62, s3, 5
    v_xor_b32 v75, s62, v75
    v_mov_b32 v77, v75
    s_cmp_eq_u32 s6, 0
    s_cbranch_scc1 L_wl_50
    ds_read_b64_tr_b16 v[4:5], v75 offset:0
    ds_read_b64_tr_b16 v[6:7], v75 offset:512
    ds_read_b64_tr_b16 v[8:9], v75 offset:4096
    ds_read_b64_tr_b16 v[10:11], v75 offset:4608
    ds_read_b64_tr_b16 v[12:13], v75 offset:8192
    ds_read_b64_tr_b16 v[14:15], v75 offset:8704
    ds_read_b64_tr_b16 v[16:17], v75 offset:12288
    ds_read_b64_tr_b16 v[18:19], v75 offset:12800
    ds_read_b64_tr_b16 v[20:21], v75 offset:16384
    ds_read_b64_tr_b16 v[22:23], v75 offset:16896
    ds_read_b64_tr_b16 v[24:25], v75 offset:20480
    ds_read_b64_tr_b16 v[26:27], v75 offset:20992
    ds_read_b64_tr_b16 v[28:29], v75 offset:24576
    ds_read_b64_tr_b16 v[30:31], v75 offset:25088
    ds_read_b64_tr_b16 v[32:33], v75 offset:28672
    ds_read_b64_tr_b16 v[34:35], v75 offset:29184
L_wl_50:
    v_and_b32 v1, 3, v0
    v_lshrrev_b32 v2, 4, v0
    v_mul_u32_u24 v1, 576, v1
    v_lshl_add_u32 v75, v2, 4, v1
    s_mul_i32 s88, s6, 245760
    s_add_u32 s88, s88, 229376
    s_lshl_b32 s62, s55, 10
    s_lshl_b32 s63, s3, 8
    s_add_u32 s62, s62, s63
    s_add_u32 s62, s62, s88
    v_lshl_add_u32 v76, v0, 4, s62
    s_mul_i32 s62, s47, 0x01010101
    v_bfe_u32 v78, v0, 0, 2
    v_lshlrev_b32 v78, 3, v78
    v_lshrrev_b32 v78, v78, s62
    s_waitcnt lgkmcnt(0)
    v_readfirstlane_b32 s56, v47
    s_barrier
    buffer_load_dwordx3 v[48:50], v72, s[16:19], 0 offen offset:768 sc1
    buffer_load_dwordx3 v[52:54], v72, s[16:19], 0 offen offset:1664 sc1
    s_waitcnt vmcnt(0)
    v_cmp_ne_u32 vcc, s47, v50
    v_cmp_ne_u32 s[62:63], s47, v54
    s_nop 0
    s_or_b64 vcc, vcc, s[62:63]
    s_cbranch_vccz L_pb_52
L_pa_51:
    buffer_load_dwordx3 v[48:50], v72, s[16:19], 0 offen offset:768 sc1
    buffer_load_dwordx3 v[52:54], v72, s[16:19], 0 offen offset:1664 sc1
    s_sub_u32 s58, s58, 1
    s_waitcnt vmcnt(0)
    s_cbranch_scc1 L_end
    v_cmp_ne_u32 vcc, s47, v50
    v_cmp_ne_u32 s[62:63], s47, v54
    s_nop 0
    s_or_b64 vcc, vcc, s[62:63]
    s_cbranch_vccnz L_pa_51
L_pb_52:
    buffer_load_dwordx4 v[56:59], v73, s[16:19], 0 offen sc1
    buffer_load_dwordx4 v[60:63], v73, s[16:19], 0 offen offset:896 sc1
    v_sub_f32 v66, v52, v48
    v_exp_f32 v67, v66
    v_exp_f32 v66, -v66
    v_fma_f32 v67, v67, v53, v49
    v_fma_f32 v66, v66, v49, v53
    v_rcp_f32 v67, v67
    v_rcp_f32 v66, v66
L_pw_53:
    s_waitcnt vmcnt(0)
    v_cmp_ne_u32_sdwa vcc, v56, v78 src0_sel:BYTE_0 src1_sel:BYTE_0
    v_mul_f32 v58, v67, v58
    v_and_b32 v56, 0xffffff00, v56
    v_mul_f32 v59, v67, v59
    v_cmp_ne_u32_sdwa s[62:63], v60, v78 src0_sel:BYTE_0 src1_sel:BYTE_0
    v_mul_f32 v57, v67, v57
    v_and_b32 v60, 0xffffff00, v60
    v_mul_f32 v56, v67, v56
    v_fmac_f32 v58, v66, v62
    v_fmac_f32 v59, v66, v63
    v_fmac_f32 v57, v66, v61
    v_fmac_f32 v56, v66, v60
    v_cvt_pk_bf16_f32 v65, v58, v59
    v_cvt_pk_bf16_f32 v64, v56, v57
    ds_write_b64 v74, v[64:65] offset:13984
    s_or_b64 vcc, vcc, s[62:63]
    s_cbranch_vccnz L_retry_54
    s_cmp_eq_u32 s6, 0
    s_cbranch_scc0 L_p0_56
    s_waitcnt lgkmcnt(0)
    s_barrier
    ds_read_b64_tr_b16 v[4:5], v77 offset:0
    ds_read_b64_tr_b16 v[6:7], v77 offset:512
    ds_read_b128 v[36:39], v75 offset:13984
    ds_read_b64_tr_b16 v[8:9], v77 offset:4096
    ds_read_b64_tr_b16 v[10:11], v77 offset:4608
    ds_read_b128 v[40:43], v75 offset:14048
    ds_read_b64_tr_b16 v[12:13], v77 offset:8192
    ds_read_b64_tr_b16 v[14:15], v77 offset:8704
    ds_read_b128 v[44:47], v75 offset:14112
    ds_read_b64_tr_b16 v[16:17], v77 offset:12288
    ds_read_b64_tr_b16 v[18:19], v77 offset:12800
    ds_read_b128 v[48:51], v75 offset:14176
    ds_read_b64_tr_b16 v[20:21], v77 offset:16384
    ds_read_b64_tr_b16 v[22:23], v77 offset:16896
    ds_read_b128 v[52:55], v75 offset:14240
    ds_read_b64_tr_b16 v[24:25], v77 offset:20480
    ds_read_b64_tr_b16 v[26:27], v77 offset:20992
    ds_read_b128 v[56:59], v75 offset:14304
    ds_read_b64_tr_b16 v[28:29], v77 offset:24576
    ds_read_b64_tr_b16 v[30:31], v77 offset:25088
    ds_read_b128 v[60:63], v75 offset:14368
    ds_read_b64_tr_b16 v[32:33], v77 offset:28672
    ds_read_b64_tr_b16 v[34:35], v77 offset:29184
    ds_read_b128 v[64:67], v75 offset:14432
    s_waitcnt lgkmcnt(15)
    v_mfma_f32_16x16x32_bf16 v[68:71], v[36:39], v[4:7], 0
    s_waitcnt lgkmcnt(15)
    v_mfma_f32_16x16x32_bf16 v[68:71], v[40:43], v[8:11], v[68:71]
    s_waitcnt lgkmcnt(15)
    v_mfma_f32_16x16x32_bf16 v[68:71], v[44:47], v[12:15], v[68:71]
    s_waitcnt lgkmcnt(12)
    v_mfma_f32_16x16x32_bf16 v[68:71], v[48:51], v[16:19], v[68:71]
    s_waitcnt lgkmcnt(9)
    v_mfma_f32_16x16x32_bf16 v[68:71], v[52:55], v[20:23], v[68:71]
    s_waitcnt lgkmcnt(6)
    v_mfma_f32_16x16x32_bf16 v[68:71], v[56:59], v[24:27], v[68:71]
    s_waitcnt lgkmcnt(3)
    v_mfma_f32_16x16x32_bf16 v[68:71], v[60:63], v[28:31], v[68:71]
    s_waitcnt lgkmcnt(0)
    v_mfma_f32_16x16x32_bf16 v[68:71], v[64:67], v[32:35], v[68:71]
    s_and_b32 exec_lo, s60, 0xffff
    s_and_b32 exec_hi, s60, 0x0
    s_nop 5
    buffer_store_dwordx4 v[68:71], v76, s[16:19], 0 offen sc1
    s_mov_b64 exec, s[60:61]
    s_branch L_wogo_55
L_p0_56:
    s_waitcnt lgkmcnt(0)
    s_barrier
    ds_read_b128 v[36:39], v75 offset:13984
    ds_read_b128 v[40:43], v75 offset:14048
    ds_read_b128 v[44:47], v75 offset:14112
    ds_read_b128 v[48:51], v75 offset:14176
    ds_read_b128 v[52:55], v75 offset:14240
    ds_read_b128 v[56:59], v75 offset:14304
    ds_read_b128 v[60:63], v75 offset:14368
    ds_read_b128 v[64:67], v75 offset:14432
    s_waitcnt lgkmcnt(7)
    v_mfma_f32_16x16x32_bf16 v[68:71], v[36:39], v[4:7], 0
    s_waitcnt lgkmcnt(6)
    v_mfma_f32_16x16x32_bf16 v[68:71], v[40:43], v[8:11], v[68:71]
    s_waitcnt lgkmcnt(5)
    v_mfma_f32_16x16x32_bf16 v[68:71], v[44:47], v[12:15], v[68:71]
    s_waitcnt lgkmcnt(4)
    v_mfma_f32_16x16x32_bf16 v[68:71], v[48:51], v[16:19], v[68:71]
    s_waitcnt lgkmcnt(3)
    v_mfma_f32_16x16x32_bf16 v[68:71], v[52:55], v[20:23], v[68:71]
    s_waitcnt lgkmcnt(2)
    v_mfma_f32_16x16x32_bf16 v[68:71], v[56:59], v[24:27], v[68:71]
    s_waitcnt lgkmcnt(1)
    v_mfma_f32_16x16x32_bf16 v[68:71], v[60:63], v[28:31], v[68:71]
    s_waitcnt lgkmcnt(0)
    v_mfma_f32_16x16x32_bf16 v[68:71], v[64:67], v[32:35], v[68:71]
    s_and_b32 exec_lo, s60, 0xffff
    s_and_b32 exec_hi, s60, 0x0
    s_nop 5
    buffer_store_dwordx4 v[68:71], v76, s[16:19], 0 offen sc1
    s_mov_b64 exec, s[60:61]
    s_branch L_wogo_55
L_role_49:
    s_barrier
    s_cmp_eq_u32 s6, 0
    s_cbranch_scc0 L_p0_61
    s_bitcmp1_b32 s57, 2
    s_cbranch_scc0 L_role_62
    s_lshr_b32 s62, s5, 3
    s_mul_i32 s62, s62, 3
    s_and_b32 s63, s3, 3
    s_add_u32 s62, s62, s63
    s_lshr_b32 s63, s62, 2
    s_mul_i32 s63, s63, 10
    s_lshl_b32 s88, s4, 5
    s_add_u32 s63, s63, s88
    s_mul_i32 s63, s63, 5248
    s_add_u32 s63, s63, 1900544
    s_and_b32 s62, s62, 3
    s_lshl_b32 s62, s62, 8
    s_add_u32 s62, s62, s63
    s_add_u32 s62, s62, 4224
    v_lshrrev_b32 v1, 4, v0
    v_and_b32 v2, 15, v0
    v_mul_u32_u24 v36, 5248, v1
    v_lshl_add_u32 v36, v2, 4, v36
    v_add_u32 v36, s62, v36
    v_add_u32 v37, 41984, v36
    v_mov_b32 v3, 2146435072
    v_cmp_gt_u32 vcc, 32, v0
    s_nop 1
    v_cndmask_b32 v37, v3, v37, vcc
    v_lshlrev_b32 v40, 4, v2
    v_lshl_add_u32 v40, v1, 2, v40
    s_and_b32 s62, s3, 3
    s_lshl_b32 s62, s62, 8
    v_add_u32 v40, s62, v40
    s_mul_i32 s62, s47, 0x01010101
    v_bfe_u32 v24, v0, 0, 2
    v_lshlrev_b32 v24, 3, v24
    v_lshrrev_b32 v24, v24, s62
    buffer_load_dwordx4 v[12:15], v36, s[16:19], 0 offen sc1
    buffer_load_dwordx4 v[16:19], v36, s[16:19], s43 offen sc1
    buffer_load_dwordx4 v[20:23], v37, s[16:19], 0 offen sc1
L_pw_65:
    s_waitcnt vmcnt(0)
    v_cmp_ne_u32_sdwa vcc, v20, v24 src0_sel:BYTE_0 src1_sel:BYTE_0
    v_and_b32 v20, 0xffffff00, v20
    v_cmp_ne_u32_sdwa s[62:63], v12, v24 src0_sel:BYTE_0 src1_sel:BYTE_0
    v_and_b32 v12, 0xffffff00, v12
    v_cmp_ne_u32_sdwa s[88:89], v16, v24 src0_sel:BYTE_0 src1_sel:BYTE_0
    v_and_b32 v16, 0xffffff00, v16
    v_add_f32 v12, v12, v16
    v_add_f32 v13, v13, v17
    v_add_f32 v14, v14, v18
    v_add_f32 v15, v15, v19
    v_add_f32 v12, v12, v20
    v_add_f32 v13, v13, v21
    v_add_f32 v14, v14, v22
    v_add_f32 v15, v15, v23
    s_mov_b32 vcc_hi, 0
    s_or_b64 vcc, vcc, s[62:63]
    s_or_b64 vcc, vcc, s[88:89]
    v_permlane32_swap_b32 v12, v14
    v_permlane32_swap_b32 v13, v15
    v_add_f32 v12, v12, v14
    v_add_f32 v13, v13, v15
    s_nop 1
    v_permlane16_swap_b32 v12, v13
    v_add_f32 v12, v12, v13
    ds_write_b32 v40, v12 offset:16720
    s_cbranch_vccnz L_retry_66
L_role_62:
L_p0_61:
    s_barrier
    s_cmp_eq_u32 s6, 0
    s_cbranch_scc0 L_p0_68
    s_bitcmp1_b32 s57, 3
    s_cbranch_scc0 L_role_69
    v_lshlrev_b32 v1, 4, v0
    s_mul_i32 s62, s54, 2688
    s_add_u32 s62, s62, 1212416
    buffer_load_dwordx4 v[60:63], v1, s[16:19], s62 offen sc1
    buffer_load_dwordx4 v[60:63], v1, s[16:19], s62 offen offset:1024 sc1
    s_mov_b32 exec_hi, 0xff
    buffer_load_dwordx4 v[60:63], v1, s[16:19], s62 offen offset:2048 sc1
    s_mov_b32 exec_hi, -1
L_role_69:
    s_and_b32 s89, s3, 3
    v_lshrrev_b32 v1, 3, v0
    v_mul_u32_u24 v6, 3072, v1
    v_bfe_u32 v1, v0, 4, 1
    v_bfe_u32 v2, v0, 1, 2
    v_xor_b32 v1, v1, v2
    v_lshl_add_u32 v6, v1, 5, v6
    v_and_b32 v1, 1, v0
    v_lshl_add_u32 v6, v1, 4, v6
    v_xor_b32 v7, 64, v6
    v_lshrrev_b32 v1, 3, v0
    v_mul_u32_u24 v8, 1280, v1
    v_bfe_u32 v1, v0, 4, 1
    v_bfe_u32 v2, v0, 1, 2
    v_xor_b32 v1, v1, v2
    v_lshl_add_u32 v8, v1, 5, v8
    v_and_b32 v1, 1, v0
    v_lshl_add_u32 v8, v1, 4, v8
    v_xor_b32 v9, 64, v8
    s_mul_i32 s88, s89, 49152
    s_lshl_b32 s63, s89, 11
    s_add_u32 m0, s63, 31872
    s_add_u32 s62, s88, 0
    buffer_load_dwordx4 v6, s[28:31], s62 offen nt lds
    s_add_u32 m0, s63, 32896
    s_add_u32 s62, s88, 24576
    buffer_load_dwordx4 v7, s[28:31], s62 offen nt lds
    s_add_u32 m0, s63, 40064
    s_add_u32 s62, s88, 0
    buffer_load_dwordx4 v6, s[32:35], s62 offen nt lds
    s_add_u32 m0, s63, 41088
    s_add_u32 s62, s88, 24576
    buffer_load_dwordx4 v7, s[32:35], s62 offen nt lds
    s_mul_i32 s88, s89, 20480
    s_add_u32 m0, s63, 23680
    s_add_u32 s62, s88, 0
    buffer_load_dwordx4 v8, s[36:39], s62 offen nt lds
    s_add_u32 m0, s63, 24704
    s_add_u32 s62, s88, 10240
    buffer_load_dwordx4 v9, s[36:39], s62 offen nt lds
L_p0_68:
L_wogo_55:
    s_lshr_b32 s62, s3, 2
    s_lshl_b32 s62, s62, 13
    s_add_u32 s62, s62, 31872
    v_lshrrev_b32 v1, 4, v0
    v_bfe_u32 v2, v0, 2, 2
    v_lshl_add_u32 v35, v1, 3, v2
    v_lshlrev_b32 v35, 7, v35
    v_and_b32 v2, 3, v0
    v_lshl_add_u32 v35, v2, 3, v35
    v_bfe_u32 v2, v0, 3, 2
    v_lshl_add_u32 v35, v2, 5, v35
    v_add_u32 v35, s62, v35
    s_and_b32 s62, s3, 3
    s_lshl_b32 s62, s62, 5
    v_xor_b32 v35, s62, v35
    s_cmp_eq_u32 s6, 0
    s_cbranch_scc1 L_gw_72
    ds_read_b64_tr_b16 v[12:13], v35 offset:0
    ds_read_b64_tr_b16 v[14:15], v35 offset:512
    ds_read_b64_tr_b16 v[16:17], v35 offset:4096
    ds_read_b64_tr_b16 v[18:19], v35 offset:4608
L_gw_72:
    s_mul_i32 s88, s6, 245760
    s_add_u32 s88, s88, 229376
    s_lshl_b32 s62, s52, 10
    s_lshl_b32 s63, s3, 7
    s_add_u32 s62, s62, s63
    s_add_u32 s62, s62, s88
    v_lshrrev_b32 v1, 3, v0
    v_and_b32 v2, 7, v0
    v_mul_u32_u24 v28, 10240, v1
    v_lshl_add_u32 v28, v2, 4, v28
    v_add_u32 v28, s62, v28
    v_lshrrev_b32 v1, 4, v0
    v_mul_u32_u24 v29, 144, v1
    v_lshl_add_u32 v29, v2, 1, v29
    s_lshl_b32 s62, s3, 4
    v_add_u32 v29, s62, v29
    v_and_b32 v1, 15, v0
    v_lshrrev_b32 v2, 4, v0
    v_min_u32 v30, 5, v1
    v_mul_u32_u24 v30, 144, v30
    v_lshl_add_u32 v30, v2, 4, v30
    v_and_b32 v3, 3, v0
    v_bfe_u32 v1, v0, 2, 2
    v_add_u32 v31, 3, v3
    v_min_u32 v31, 5, v31
    v_cmp_eq_u32 vcc, 0, v3
    s_nop 1
    v_cndmask_b32 v31, v31, v1, vcc
    v_mul_u32_u24 v31, 144, v31
    v_lshl_add_u32 v31, v2, 4, v31
    s_mov_b32 s88, 1212416
    s_mul_i32 s62, s54, 2688
    s_add_u32 s62, s62, s88
    s_lshl_b32 s63, s3, 8
    s_add_u32 s63, s63, s62
    v_lshl_add_u32 v32, v0, 4, s63
    s_lshl_b32 s63, s3, 6
    s_add_u32 s63, s63, s62
    v_lshl_add_u32 v34, v0, 2, s63
    v_lshrrev_b32 v1, 4, v0
    s_add_u32 s62, s62, 2560
    v_lshl_add_u32 v33, v1, 4, s62
    s_bitcmp1_b32 s57, 0
    s_cbranch_scc0 L_role_73
    s_waitcnt vmcnt(0)
L_role_73:
    s_barrier
    s_mov_b32 s62, 23680
    v_lshrrev_b32 v1, 4, v0
    v_bfe_u32 v2, v0, 2, 2
    v_lshl_add_u32 v47, v1, 3, v2
    v_lshlrev_b32 v47, 7, v47
    v_and_b32 v2, 3, v0
    v_lshl_add_u32 v47, v2, 3, v47
    v_bfe_u32 v2, v0, 3, 2
    v_lshl_add_u32 v47, v2, 5, v47
    v_add_u32 v47, s62, v47
    s_lshl_b32 s62, s3, 5
    v_xor_b32 v47, s62, v47
    v_and_b32 v1, 3, v0
    v_lshrrev_b32 v2, 4, v0
    v_mul_u32_u24 v1, 192, v1
    v_lshl_add_u32 v78, v2, 4, v1
    s_mul_i32 s88, s6, 245760
    s_add_u32 s88, s88, 720896
    s_lshl_b32 s62, s55, 10
    s_lshl_b32 s63, s3, 8
    s_add_u32 s62, s62, s63
    s_add_u32 s62, s62, s88
    v_lshl_add_u32 v79, v0, 4, s62
    s_mov_b32 s89, 1212416
    s_mul_i32 s88, s53, 10
    s_lshl_b32 s62, s4, 5
    s_add_u32 s88, s88, s62
    s_mul_i32 s88, s88, 2688
    s_add_u32 s88, s88, s89
    v_lshrrev_b32 v1, 4, v0
    v_mul_u32_u24 v3, 2688, v1
    v_add_u32 v3, s88, v3
    v_bfe_u32 v2, v0, 3, 1
    v_lshlrev_b32 v2, 6, v2
    v_and_or_b32 v2, v0, 7, v2
    s_lshl_b32 s62, s3, 3
    v_add_u32 v2, s62, v2
    v_lshl_add_u32 v72, v2, 4, v3
    v_lshl_add_u32 v74, v2, 2, v3
    v_add_u32 v73, 21504, v72
    v_add_u32 v75, 21504, v74
    v_mov_b32 v3, 2146435072
    v_cmp_gt_u32 vcc, 32, v0
    s_nop 1
    v_cndmask_b32 v73, v3, v73, vcc
    v_cndmask_b32 v75, v3, v75, vcc
    v_and_b32 v2, 15, v0
    v_mul_u32_u24 v76, 2688, v2
    v_lshl_add_u32 v76, v1, 4, v76
    v_add_u32 v76, s88, v76
    v_cmp_gt_u32 vcc, 10, v2
    s_nop 1
    v_cndmask_b32 v76, v3, v76, vcc
    v_mul_u32_u24 v77, 192, v1
    v_and_b32 v2, 7, v0
    v_lshl_add_u32 v77, v2, 1, v77
    s_lshl_b32 s62, s3, 4
    v_add_u32 v77, s62, v77
    v_mov_b32 v40, 0
    v_mov_b32 v41, 0
    v_mov_b32 v42, 0
    v_mov_b32 v43, 0
    s_mul_i32 s62, s47, 0x01010101
    v_bfe_u32 v85, v0, 4, 2
    v_lshlrev_b32 v85, 3, v85
    v_lshrrev_b32 v85, v85, s62
    s_mul_i32 s62, s47, 0x01010101
    v_bfe_u32 v86, v0, 0, 2
    v_lshlrev_b32 v86, 3, v86
    v_lshrrev_b32 v86, v86, s62
    buffer_load_dwordx4 v[48:51], v28, s[16:19], 0 offen sc1
    buffer_load_dwordx4 v[52:55], v28, s[16:19], s40 offen sc1
    buffer_load_dwordx4 v[56:59], v28, s[16:19], s41 offen sc1
    s_movk_i32 s98, 0x100
L_pw_75:
    s_waitcnt vmcnt(0)
    v_add_f32 v48, v48, v52
    v_add_f32 v49, v49, v53
    v_add_f32 v50, v50, v54
    v_add_f32 v51, v51, v55
    v_add_f32 v48, v48, v56
    v_add_f32 v50, v50, v58
    v_add_f32 v49, v49, v57
    v_add_f32 v51, v51, v59
    v_permlane32_swap_b32 v48, v50
    s_nop 0
    v_permlane32_swap_b32 v49, v51
    v_add_f32 v48, v48, v50
    v_add_f32 v49, v49, v51
    s_nop 1
    v_permlane16_swap_b32 v48, v49
    v_add_f32 v48, v48, v49
    s_nop 1
    v_add_f32_dpp v48, v48, v48 row_ror:8 row_mask:0xf bank_mask:0xf
    v_cvt_pk_bf16_f32 v49, 0, v48
    v_cmp_u_f32 vcc, v48, v48
    s_cbranch_vccnz L_retry_76
L_ok_78:
    v_add_f32 v80, v80, v49
    v_cvt_pk_bf16_f32 v80, 0, v80
    ds_write_b16_d16_hi v29, v80 offset:12352
    s_cmp_eq_u32 s6, 0
    s_cbranch_scc0 L_p0_84
    s_bitcmp1_b32 s57, 5
    s_cbranch_scc0 L_role_85
    s_waitcnt lgkmcnt(0)
    s_barrier
    ds_read_b128 v[60:63], v31 offset:12352
    ds_read_b64_tr_b16 v[12:13], v35 offset:0
    ds_read_b64_tr_b16 v[14:15], v35 offset:512
    ds_read_b64_tr_b16 v[16:17], v35 offset:4096
    ds_read_b64_tr_b16 v[18:19], v35 offset:4608
    ds_read_b128 v[4:7], v30 offset:12352
    ds_read_b128 v[8:11], v30 offset:12416
    ds_read_b128 v[64:67], v31 offset:12416
    s_waitcnt lgkmcnt(2)
    v_mfma_f32_16x16x32_bf16 v[48:51], v[4:7], v[12:15], 0
    v_mfma_f32_16x16x32_bf16 v[68:71], v[60:63], v[4:7], 0
    s_waitcnt lgkmcnt(1)
    v_mfma_f32_16x16x32_bf16 v[48:51], v[8:11], v[16:19], v[48:51]
    s_waitcnt lgkmcnt(0)
    v_mfma_f32_16x16x32_bf16 v[68:71], v[64:67], v[8:11], v[68:71]
    s_nop 5
    v_mov_b32_sdwa v48, v86 dst_sel:BYTE_0 dst_unused:UNUSED_PRESERVE src0_sel:BYTE_0
    s_and_b32 exec_lo, s60, 0xffff
    s_and_b32 exec_hi, s60, 0x0
    s_cmp_eq_u32 s56, 0
    s_cbranch_scc1 L_st_87
    buffer_store_dwordx4 v[48:51], v32, s[16:19], 0 offen
    s_mov_b32 exec_lo, 0xffff0000
    buffer_store_dword v48, v34, s[16:19], 0 offen offset:1984
    s_mov_b64 exec, -1
    v_mov_b32_dpp v71, v70 row_newbcast:4 row_mask:0xf bank_mask:0xf
    v_mov_b32_sdwa v71, v85 dst_sel:BYTE_0 dst_unused:UNUSED_PRESERVE src0_sel:BYTE_0
    s_mov_b32 exec_lo, 0x20001
    s_mov_b32 exec_hi, 0x80004
    buffer_store_dwordx4 v[68:71], v33, s[16:19], 0 offen
L_st_88:
    s_mov_b64 exec, s[60:61]
    s_branch L_gr_83
L_role_85:
    s_waitcnt lgkmcnt(0)
    s_barrier
    ds_read_b64_tr_b16 v[12:13], v35 offset:0
    ds_read_b64_tr_b16 v[14:15], v35 offset:512
    ds_read_b64_tr_b16 v[16:17], v35 offset:4096
    ds_read_b64_tr_b16 v[18:19], v35 offset:4608
    ds_read_b128 v[4:7], v30 offset:12352
    ds_read_b128 v[8:11], v30 offset:12416
    s_waitcnt lgkmcnt(1)
    v_mfma_f32_16x16x32_bf16 v[48:51], v[4:7], v[12:15], 0
    s_waitcnt lgkmcnt(0)
    v_mfma_f32_16x16x32_bf16 v[48:51], v[8:11], v[16:19], v[48:51]
    s_nop 7
    v_mov_b32_sdwa v48, v86 dst_sel:BYTE_0 dst_unused:UNUSED_PRESERVE src0_sel:BYTE_0
    s_and_b32 exec_lo, s60, 0xffff
    s_and_b32 exec_hi, s60, 0x0
    s_cmp_eq_u32 s56, 0
    s_cbranch_scc1 L_st_90
    buffer_store_dwordx4 v[48:51], v32, s[16:19], 0 offen
    s_mov_b32 exec_lo, 0xffff0000
    buffer_store_dword v48, v34, s[16:19], 0 offen offset:1984
L_st_91:
    s_mov_b64 exec, s[60:61]
    s_branch L_gr_83
L_p0_84:
    s_bitcmp1_b32 s57, 5
    s_cbranch_scc0 L_role_92
    s_waitcnt lgkmcnt(0)
    s_barrier
    ds_read_b128 v[60:63], v31 offset:12352
    ds_read_b128 v[4:7], v30 offset:12352
    ds_read_b128 v[8:11], v30 offset:12416
    ds_read_b128 v[64:67], v31 offset:12416
    s_waitcnt lgkmcnt(2)
    v_mfma_f32_16x16x32_bf16 v[48:51], v[4:7], v[12:15], 0
    v_mfma_f32_16x16x32_bf16 v[68:71], v[60:63], v[4:7], 0
    s_waitcnt lgkmcnt(1)
    v_mfma_f32_16x16x32_bf16 v[48:51], v[8:11], v[16:19], v[48:51]
    s_waitcnt lgkmcnt(0)
    v_mfma_f32_16x16x32_bf16 v[68:71], v[64:67], v[8:11], v[68:71]
    s_nop 5
    v_mov_b32_sdwa v48, v86 dst_sel:BYTE_0 dst_unused:UNUSED_PRESERVE src0_sel:BYTE_0
    s_and_b32 exec_lo, s60, 0xffff
    s_and_b32 exec_hi, s60, 0x0
    s_cmp_eq_u32 s56, 0
    s_cbranch_scc1 L_st_94
    buffer_store_dwordx4 v[48:51], v32, s[16:19], 0 offen
    s_mov_b32 exec_lo, 0x20001
    s_mov_b32 exec_hi, 0x80004
    v_mov_b32 v71, v85
    buffer_store_dwordx4 v[68:71], v33, s[16:19], 0 offen
L_st_95:
    s_mov_b64 exec, s[60:61]
    s_branch L_gr_83
L_role_92:
    s_waitcnt lgkmcnt(0)
    s_barrier
    ds_read_b128 v[4:7], v30 offset:12352
    ds_read_b128 v[8:11], v30 offset:12416
    s_waitcnt lgkmcnt(1)
    v_mfma_f32_16x16x32_bf16 v[48:51], v[4:7], v[12:15], 0
    s_waitcnt lgkmcnt(0)
    v_mfma_f32_16x16x32_bf16 v[48:51], v[8:11], v[16:19], v[48:51]
    s_nop 7
    v_mov_b32_sdwa v48, v86 dst_sel:BYTE_0 dst_unused:UNUSED_PRESERVE src0_sel:BYTE_0
    s_and_b32 exec_lo, s60, 0xffff
    s_and_b32 exec_hi, s60, 0x0
    s_cmp_eq_u32 s56, 0
    s_cbranch_scc1 L_st_97
    buffer_store_dwordx4 v[48:51], v32, s[16:19], 0 offen
L_st_98:
    s_mov_b64 exec, s[60:61]
L_gr_83:
    s_barrier
    s_mov_b32 exec_lo, 0x3ff03ff
    s_mov_b32 exec_hi, 0x3ff03ff
    buffer_load_dwordx4 v[40:43], v76, s[16:19], 0 offen offset:2560 sc1
    s_mov_b64 exec, -1
    s_bitcmp1_b32 s57, 0
    s_cbranch_scc0 L_role_103
    ds_read_b64_tr_b16 v[20:21], v47 offset:0
    ds_read_b64_tr_b16 v[22:23], v47 offset:512
    ds_read_b64_tr_b16 v[24:25], v47 offset:4096
    ds_read_b64_tr_b16 v[26:27], v47 offset:4608
L_role_103:
    s_mov_b32 exec_lo, 0x3ff03ff
    s_mov_b32 exec_hi, 0x3ff03ff
    s_waitcnt vmcnt(0)
    v_cmp_ne_u32_sdwa vcc, v43, v85 src0_sel:BYTE_0 src1_sel:BYTE_0
    s_cbranch_vccz L_pb_100
L_pa_99:
    buffer_load_dwordx4 v[40:43], v76, s[16:19], 0 offen offset:2560 sc1
    s_sub_u32 s58, s58, 1
    s_waitcnt vmcnt(0)
    s_cbranch_scc1 L_end
    v_cmp_ne_u32_sdwa vcc, v43, v85 src0_sel:BYTE_0 src1_sel:BYTE_0
    s_cbranch_vccnz L_pa_99
L_pb_100:
    s_mov_b64 exec, -1
    buffer_load_dwordx4 v[52:55], v72, s[16:19], 0 offen sc1
    buffer_load_dwordx4 v[56:59], v72, s[16:19], s42 offen sc1
    buffer_load_dwordx4 v[60:63], v73, s[16:19], 0 offen sc1
    s_cmp_eq_u32 s6, 0
    s_cbranch_scc0 L_p0_104
    buffer_load_dword v44, v74, s[16:19], 0 offen offset:2048 sc1
    buffer_load_dword v45, v74, s[16:19], s42 offen offset:2048 sc1
    buffer_load_dword v46, v75, s[16:19], 0 offen offset:2048 sc1
L_p0_104:
    v_add_f32_dpp v40, v40, v40 quad_perm:[1,0,3,2] row_mask:0xf bank_mask:0xf
    v_add_f32_dpp v41, v41, v41 quad_perm:[1,0,3,2] row_mask:0xf bank_mask:0xf
    s_nop 0
    v_add_f32_dpp v40, v40, v40 quad_perm:[2,3,0,1] row_mask:0xf bank_mask:0xf
    v_add_f32_dpp v41, v41, v41 quad_perm:[2,3,0,1] row_mask:0xf bank_mask:0xf
    s_nop 0
    v_add_f32_dpp v40, v40, v40 row_half_mirror row_mask:0xf bank_mask:0xf
    v_add_f32_dpp v41, v41, v41 row_half_mirror row_mask:0xf bank_mask:0xf
    s_nop 0
    v_add_f32_dpp v40, v40, v40 row_mirror row_mask:0xf bank_mask:0xf
    v_add_f32_dpp v41, v41, v41 row_mirror row_mask:0xf bank_mask:0xf
    v_mul_f32 v41, s95, v41
    v_mul_f32 v40, s95, v40
    v_fma_f32 v39, -v41, v41, v40
    v_cvt_pk_bf16_f32 v37, 0, v41
    v_max_f32 v39, 0, v39
    v_cvt_pk_bf16_f32 v39, 0, v39
    v_add_f32 v39, s59, v39
    v_cvt_pk_bf16_f32 v39, 0, v39
    v_sqrt_f32 v39, v39
    s_nop 0
    v_cvt_pk_bf16_f32 v39, 0, v39
    v_rcp_f32 v38, v39
L_pw_101:
    s_waitcnt vmcnt(0)
    s_cmp_eq_u32 s6, 0
    s_cbranch_scc0 L_p0_105
    v_cmp_ne_u32_sdwa vcc, v60, v86 src0_sel:BYTE_0 src1_sel:BYTE_0
    v_add_f32 v53, v53, v57
    v_and_b32 v60, 0xffffff00, v60
    v_add_f32 v54, v54, v58
    v_cmp_ne_u32_sdwa s[62:63], v46, v86 src0_sel:BYTE_0 src1_sel:BYTE_0
    v_add_f32 v55, v55, v59
    v_and_b32 v46, 0xffffff00, v46
    v_add_f32 v54, v54, v62
    v_cmp_ne_u32_sdwa s[88:89], v52, v86 src0_sel:BYTE_0 src1_sel:BYTE_0
    v_add_f32 v53, v53, v61
    v_and_b32 v52, 0xffffff00, v52
    v_add_f32 v55, v55, v63
    v_cmp_ne_u32_sdwa s[90:91], v56, v86 src0_sel:BYTE_0 src1_sel:BYTE_0
    v_and_b32 v56, 0xffffff00, v56
    v_cmp_ne_u32_sdwa s[96:97], v44, v86 src0_sel:BYTE_0 src1_sel:BYTE_0
    v_and_b32 v44, 0xffffff00, v44
    v_cmp_ne_u32_sdwa s[98:99], v45, v86 src0_sel:BYTE_0 src1_sel:BYTE_0
    v_and_b32 v45, 0xffffff00, v45
    v_add_f32 v52, v52, v56
    v_add_f32 v35, v44, v45
    s_or_b64 vcc, vcc, s[62:63]
    v_add_f32 v52, v52, v60
    v_add_f32 v35, v35, v46
    s_mov_b32 vcc_hi, 0
    v_permlane32_swap_b32 v52, v54
    v_mov_b32 v36, v35
    s_or_b64 vcc, vcc, s[88:89]
    v_permlane32_swap_b32 v53, v55
    v_permlane32_swap_b32 v35, v36
    s_or_b64 vcc, vcc, s[90:91]
    v_add_f32 v52, v52, v54
    v_add_f32 v35, v35, v36
    s_or_b64 vcc, vcc, s[96:97]
    v_add_f32 v53, v53, v55
    v_mov_b32 v36, v35
    s_or_b64 vcc, vcc, s[98:99]
    v_permlane16_swap_b32 v52, v53
    v_permlane16_swap_b32 v35, v36
    v_add_f32 v52, v52, v53
    v_add_f32 v83, v35, v36
    s_branch L_rv_106
L_p0_105:
    v_cmp_ne_u32_sdwa vcc, v60, v86 src0_sel:BYTE_0 src1_sel:BYTE_0
    v_add_f32 v53, v53, v57
    v_and_b32 v60, 0xffffff00, v60
    v_add_f32 v54, v54, v58
    v_cmp_ne_u32_sdwa s[62:63], v52, v86 src0_sel:BYTE_0 src1_sel:BYTE_0
    v_add_f32 v55, v55, v59
    v_and_b32 v52, 0xffffff00, v52
    v_add_f32 v54, v54, v62
    v_cmp_ne_u32_sdwa s[88:89], v56, v86 src0_sel:BYTE_0 src1_sel:BYTE_0
    v_add_f32 v53, v53, v61
    v_and_b32 v56, 0xffffff00, v56
    v_add_f32 v55, v55, v63
    v_add_f32 v52, v52, v56
    v_add_f32 v52, v52, v60
    s_nop 1
    v_permlane32_swap_b32 v52, v54
    v_permlane32_swap_b32 v53, v55
    v_add_f32 v52, v52, v54
    s_mov_b32 vcc_hi, 0
    v_add_f32 v53, v53, v55
    s_or_b64 vcc, vcc, s[62:63]
    s_nop 0
    v_permlane16_swap_b32 v52, v53
    s_or_b64 vcc, vcc, s[88:89]
    v_add_f32 v52, v52, v53
L_rv_106:
    v_fma_f32 v52, -v37, v83, v52
    v_mul_f32 v52, v52, v38
    v_cvt_pk_bf16_f32 v53, 0, v52
    v_mul_f32 v54, s93, v53
    v_exp_f32 v54, -v54
    s_nop 0
    v_add_f32 v54, 1.0, v54
    v_rcp_f32 v54, v54
    s_nop 0
    v_mul_f32 v54, v53, v54
    v_cvt_pk_bf16_f32 v54, 0, v54
    s_nop 1
    v_mul_f32_dpp v54, v53, v54 row_ror:8 row_mask:0xf bank_mask:0xf
    s_and_b32 exec_lo, s60, 0xff00ff
    s_and_b32 exec_hi, s60, 0xff00ff
    v_cvt_pk_bf16_f32 v54, 0, v54
    ds_write_b16_d16_hi v77, v54 offset:13216
    s_mov_b64 exec, s[60:61]
    s_cbranch_vccnz L_retry_102
    s_bitcmp1_b32 s57, 0
    s_cbranch_scc0 L_role_108
    s_waitcnt lgkmcnt(0)
    s_barrier
    ds_read_b128 v[4:7], v78 offset:13216
    ds_read_b128 v[8:11], v78 offset:13280
    s_waitcnt lgkmcnt(1)
    v_mfma_f32_16x16x32_bf16 v[68:71], v[4:7], v[20:23], 0
    s_waitcnt lgkmcnt(0)
    v_mfma_f32_16x16x32_bf16 v[68:71], v[8:11], v[24:27], v[68:71]
    s_and_b32 exec_lo, s60, 0xffff
    s_and_b32 exec_hi, s60, 0x0
    s_nop 5
    buffer_store_dwordx4 v[68:71], v79, s[16:19], 0 offen sc1
    s_mov_b64 exec, s[60:61]
    s_branch L_dn_109
L_role_108:
    s_waitcnt lgkmcnt(0)
    s_barrier
L_dn_109:
    v_and_b32 v43, 0xffffff00, v43
    v_add_f32_dpp v42, v42, v42 quad_perm:[1,0,3,2] row_mask:0xf bank_mask:0xf
    s_nop 0
    v_add_f32_dpp v43, v43, v43 quad_perm:[1,0,3,2] row_mask:0xf bank_mask:0xf
    v_add_f32_dpp v42, v42, v42 quad_perm:[2,3,0,1] row_mask:0xf bank_mask:0xf
    s_nop 0
    v_add_f32_dpp v43, v43, v43 quad_perm:[2,3,0,1] row_mask:0xf bank_mask:0xf
    v_add_f32_dpp v42, v42, v42 row_half_mirror row_mask:0xf bank_mask:0xf
    s_nop 0
    v_add_f32_dpp v43, v43, v43 row_half_mirror row_mask:0xf bank_mask:0xf
    v_add_f32_dpp v42, v42, v42 row_mirror row_mask:0xf bank_mask:0xf
    s_nop 0
    v_add_f32_dpp v43, v43, v43 row_mirror row_mask:0xf bank_mask:0xf
    s_cmp_eq_u32 s6, 0
    s_cbranch_scc0 L_p0_113
    v_readfirstlane_b32 s46, v43
L_p0_113:
    s_nop 1
    v_mov_b32 v43, s46
    v_fma_f32 v42, -v37, v43, v42
    v_mul_f32 v42, v42, v38
    v_cvt_pk_bf16_f32 v42, 0, v42
    v_mul_f32 v42, s93, v42
    v_exp_f32 v42, -v42
    v_sub_f32 v81, v80, v37
    v_add_f32 v42, 1.0, v42
    v_rcp_f32 v42, v42
    v_cvt_pk_bf16_f32 v81, 0, v81
    v_cvt_pk_bf16_f32 v82, 0, v42
    v_mul_f32 v81, v81, v38
    v_cvt_pk_bf16_f32 v81, 0, v81
    s_cmp_eq_u32 s6, 1
    s_cbranch_scc1 L_final
    s_add_u32 s47, s101, 1
    s_bitcmp1_b32 s57, 1
    s_cbranch_scc0 L_role_114
    v_lshlrev_b32 v1, 4, v0
    s_and_b32 s63, s3, 3
    s_lshl_b32 s63, s63, 10
    s_mul_i32 s62, s54, 5248
    s_add_u32 s62, s62, 1900544
    s_add_u32 s63, s62, s63
    buffer_load_dwordx4 v[60:63], v1, s[16:19], s63 offen sc1
    s_cmp_eq_u32 s3, 7
    s_cbranch_scc0 L_pw_116
    s_add_u32 s62, s62, 4096
    s_mov_b64 exec, 0xff
    buffer_load_dwordx4 v[60:63], v1, s[16:19], s62 offen sc1
L_pw_116:
    s_mov_b64 exec, -1
L_role_114:
    s_lshr_b32 s62, s3, 1
    s_lshl_b32 s62, s62, 13
    s_add_u32 s62, s62, 81024
    v_lshrrev_b32 v1, 4, v0
    v_bfe_u32 v2, v0, 2, 2
    v_lshl_add_u32 v34, v1, 3, v2
    v_lshlrev_b32 v34, 7, v34
    v_and_b32 v2, 3, v0
    v_lshl_add_u32 v34, v2, 3, v34
    v_bfe_u32 v2, v0, 3, 2
    v_lshl_add_u32 v34, v2, 5, v34
    v_add_u32 v34, s62, v34
    s_and_b32 s62, s3, 1
    s_lshl_b32 s62, s62, 6
    v_xor_b32 v34, s62, v34
    v_xor_b32 v35, 32, v34
    ds_read_b64_tr_b16 v[12:13], v34 offset:0
    ds_read_b64_tr_b16 v[14:15], v34 offset:512
    ds_read_b64_tr_b16 v[16:17], v34 offset:4096
    ds_read_b64_tr_b16 v[18:19], v34 offset:4608
    ds_read_b64_tr_b16 v[20:21], v35 offset:0
    ds_read_b64_tr_b16 v[22:23], v35 offset:512
    ds_read_b64_tr_b16 v[24:25], v35 offset:4096
    ds_read_b64_tr_b16 v[26:27], v35 offset:4608
    s_mul_i32 s62, s47, 0x01010101
    v_bfe_u32 v42, v0, 4, 2
    v_lshlrev_b32 v42, 3, v42
    v_lshrrev_b32 v42, v42, s62
L_ycommon:
    v_lshrrev_b32 v1, 4, v0
    v_mul_u32_u24 v41, 1280, v1
    v_and_b32 v2, 7, v0
    v_lshl_add_u32 v41, v2, 1, v41
    s_lshl_b32 s62, s52, 7
    s_lshl_b32 s63, s3, 4
    s_add_u32 s62, s62, s63
    v_add_u32 v41, s62, v41
    s_cmp_eq_u32 s6, 1
    s_cselect_b32 s62, 0x00ff00ff, 0
    s_mov_b32 s63, s62
    v_mov_b32 v3, 2146435072
    v_cndmask_b32 v41, v3, v41, s[62:63]
    s_mul_i32 s88, s6, 245760
    s_add_u32 s88, s88, 720896
    s_lshl_b32 s62, s52, 10
    s_lshl_b32 s63, s3, 7
    s_add_u32 s62, s62, s63
    s_add_u32 s62, s62, s88
    v_lshrrev_b32 v1, 3, v0
    v_and_b32 v2, 7, v0
    v_mul_u32_u24 v28, 10240, v1
    v_lshl_add_u32 v28, v2, 4, v28
    v_add_u32 v28, s62, v28
    v_lshrrev_b32 v1, 4, v0
    v_mul_u32_u24 v29, 144, v1
    v_lshl_add_u32 v29, v2, 1, v29
    s_lshl_b32 s62, s3, 4
    v_add_u32 v29, s62, v29
    v_and_b32 v1, 15, v0
    v_lshrrev_b32 v2, 4, v0
    v_min_u32 v30, 5, v1
    v_mul_u32_u24 v30, 144, v30
    v_lshl_add_u32 v30, v2, 4, v30
    v_and_b32 v3, 3, v0
    v_bfe_u32 v1, v0, 2, 2
    v_add_u32 v31, 3, v3
    v_min_u32 v31, 5, v31
    v_cmp_eq_u32 vcc, 0, v3
    s_nop 1
    v_cndmask_b32 v31, v31, v1, vcc
    v_mul_u32_u24 v31, 144, v31
    v_lshl_add_u32 v31, v2, 4, v31
    v_and_b32 v1, 15, v0
    v_lshlrev_b32 v32, 10, v1
    v_lshrrev_b32 v1, 4, v0
    v_lshl_add_u32 v32, v1, 4, v32
    s_mul_i32 s63, s54, 5248
    s_add_u32 s63, s63, 1900544
    s_lshl_b32 s62, s3, 7
    s_add_u32 s62, s62, s63
    v_add_u32 v32, s62, v32
    s_add_u32 s63, s63, 4096
    v_lshl_add_u32 v33, v1, 4, s63
    s_bitcmp1_b32 s57, 0
    s_cbranch_scc0 L_role_118
    s_waitcnt vmcnt(0)
L_role_118:
    s_barrier
    s_cmp_eq_u32 s6, 0
    s_cbranch_scc0 L_p0_120
    v_lshrrev_b32 v1, 4, v0
    v_and_b32 v2, 3, v0
    v_lshlrev_b32 v2, 4, v2
    v_lshl_add_u32 v76, v1, 6, v2
    v_and_b32 v3, 0x40, v76
    v_add3_u32 v77, v3, v2, 64
    v_add_u32 v77, 192, v77
    v_bfe_u32 v2, v0, 2, 2
    v_mov_b32 v3, 384
    v_cmp_eq_u32 vcc, 0, v2
    s_nop 1
    v_cndmask_b32 v72, v3, v76, vcc
    v_cmp_eq_u32 vcc, 1, v2
    s_nop 1
    v_cndmask_b32 v73, v3, v76, vcc
    v_cmp_eq_u32 vcc, 2, v2
    s_nop 1
    v_cndmask_b32 v74, v3, v76, vcc
    v_cmp_eq_u32 vcc, 3, v2
    s_nop 1
    v_cndmask_b32 v75, v3, v76, vcc
    v_lshrrev_b32 v1, 5, v0
    v_cmp_eq_u32 vcc, v1, v2
    s_nop 1
    v_cndmask_b32 v76, v3, v77, vcc
    v_add_u32 v1, 2, v1
    v_cmp_eq_u32 vcc, v1, v2
    s_nop 1
    v_cndmask_b32 v77, v3, v77, vcc
    v_and_b32 v1, 1, v0
    v_mul_u32_u24 v78, 0xaaaa, v1
    v_add_u32 v78, 0x4444, v78
    v_and_b32 v1, 3, v0
    v_xor_b32 v2, 1, v1
    v_lshl_add_u32 v79, v2, 2, v1
    v_mul_u32_u24 v79, 0x1111, v79
    v_bfe_u32 v1, v0, 2, 1
    v_mul_u32_u24 v85, 0xffff, v1
    v_sub_u32 v84, 0xffff, v85
    s_mul_i32 s62, s3, 6144
    s_add_u32 s62, s62, 113792
    v_lshl_add_u32 v86, v0, 4, s62
    v_and_b32 v1, 7, v0
    v_lshlrev_b32 v1, 5, v1
    v_bfe_u32 v2, v0, 4, 1
    v_lshl_add_u32 v1, v2, 4, v1
    v_lshrrev_b32 v2, 5, v0
    v_mul_u32_u24 v2, 768, v2
    s_mul_i32 s62, s3, 1536
    v_add3_u32 v87, v1, v2, s62
L_p0_120:
    buffer_load_dwordx4 v[48:51], v28, s[16:19], 0 offen sc1
    buffer_load_dwordx4 v[52:55], v28, s[16:19], s40 offen sc1
    buffer_load_dwordx4 v[56:59], v28, s[16:19], s41 offen sc1
    s_movk_i32 s98, 0x100
    s_bitcmp1_b32 s57, 2
    s_cbranch_scc0 L_role_128
    s_bfe_u32 s89, s5, 0x20001
    s_lshl_b32 s91, s89, 10
    s_lshr_b32 s62, s5, 3
    s_mul_i32 s62, s62, 3
    s_and_b32 s63, s3, 3
    s_add_u32 s62, s62, s63
    s_lshr_b32 s63, s62, 2
    s_mul_i32 s63, s63, 10
    s_lshl_b32 s88, s4, 5
    s_add_u32 s63, s63, s88
    s_mul_i32 s63, s63, 5248
    s_add_u32 s63, s63, 1900544
    s_and_b32 s62, s62, 3
    s_lshl_b32 s62, s62, 8
    s_add_u32 s62, s62, s63
    s_add_u32 s62, s62, s91
    v_lshrrev_b32 v1, 4, v0
    v_and_b32 v2, 15, v0
    v_mul_u32_u24 v36, 5248, v1
    v_lshl_add_u32 v36, v2, 4, v36
    v_add_u32 v36, s62, v36
    v_add_u32 v37, 41984, v36
    v_mov_b32 v3, 2146435072
    v_cmp_gt_u32 vcc, 32, v0
    s_nop 1
    v_cndmask_b32 v37, v3, v37, vcc
    v_lshlrev_b32 v40, 4, v2
    v_lshl_add_u32 v40, v1, 2, v40
    s_and_b32 s62, s3, 3
    s_lshl_b32 s62, s62, 8
    v_add_u32 v40, s62, v40
    v_mul_u32_u24 v38, 5248, v2
    s_lshl_b32 s89, s89, 4
    s_add_u32 s89, s89, s63
    s_add_u32 s89, s89, 4096
    v_add_u32 v38, s89, v38
    v_cmp_gt_u32 vcc, 10, v2
    s_nop 1
    v_cndmask_b32 v38, v3, v38, vcc
    ds_read_b32 v40, v40 offset:16720
    v_bfe_u32 v1, v0, 3, 1
    v_lshlrev_b32 v39, 6, v1
    v_bfe_u32 v1, v0, 1, 1
    v_lshl_add_u32 v39, v1, 5, v39
    v_lshrrev_b32 v1, 5, v0
    v_lshl_add_u32 v39, v1, 4, v39
    v_bfe_u32 v1, v0, 2, 1
    v_lshl_add_u32 v39, v1, 3, v39
    v_and_b32 v1, 1, v0
    v_lshl_add_u32 v39, v1, 2, v39
    v_bfe_u32 v1, v0, 4, 1
    v_lshl_add_u32 v39, v1, 1, v39
    s_lshr_b32 s62, s62, 1
    v_add_u32 v39, s62, v39
L_role_128:
L_pw_121:
    s_waitcnt vmcnt(0)
    v_add_f32 v48, v48, v52
    v_add_f32 v49, v49, v53
    v_add_f32 v50, v50, v54
    v_add_f32 v51, v51, v55
    v_add_f32 v48, v48, v56
    v_add_f32 v50, v50, v58
    v_add_f32 v49, v49, v57
    v_add_f32 v51, v51, v59
    v_permlane32_swap_b32 v48, v50
    s_nop 0
    v_permlane32_swap_b32 v49, v51
    v_add_f32 v48, v48, v50
    v_add_f32 v49, v49, v51
    s_nop 1
    v_permlane16_swap_b32 v48, v49
    v_add_f32 v48, v48, v49
    s_nop 1
    v_add_f32_dpp v48, v48, v48 row_ror:8 row_mask:0xf bank_mask:0xf
    v_cvt_pk_bf16_f32 v49, 0, v48
    v_cmp_u_f32 vcc, v48, v48
    s_cbranch_vccnz L_retry_122
L_ok_124:
    v_mul_f32 v49, v49, v82
    v_cvt_pk_bf16_f32 v49, 0, v49
    v_add_f32 v49, v81, v49
    v_cvt_pk_bf16_f32 v49, 0, v49
    v_add_f32 v80, v80, v49
    v_cvt_pk_bf16_f32 v80, 0, v80
    ds_write_b16_d16_hi v29, v80 offset:12352
    buffer_store_short_d16_hi v80, v41, s[48:51], 0 offen
    s_cmp_eq_u32 s6, 1
    s_cbranch_scc0 L_go_130
    s_endpgm
L_go_130:
    s_bitcmp1_b32 s57, 5
    s_cbranch_scc0 L_role_132
    s_waitcnt lgkmcnt(0)
    s_barrier
    ds_read_b128 v[60:63], v31 offset:12352
    ds_read_b128 v[4:7], v30 offset:12352
    ds_read_b128 v[8:11], v30 offset:12416
    ds_read_b128 v[64:67], v31 offset:12416
    s_waitcnt lgkmcnt(2)
    v_mfma_f32_16x16x32_bf16 v[48:51], v[12:15], v[4:7], 0
    v_mfma_f32_16x16x32_bf16 v[52:55], v[20:23], v[4:7], 0
    v_mfma_f32_16x16x32_bf16 v[68:71], v[60:63], v[4:7], 0
    s_waitcnt lgkmcnt(1)
    v_mfma_f32_16x16x32_bf16 v[48:51], v[16:19], v[8:11], v[48:51]
    v_mfma_f32_16x16x32_bf16 v[52:55], v[24:27], v[8:11], v[52:55]
    s_waitcnt lgkmcnt(0)
    v_mfma_f32_16x16x32_bf16 v[68:71], v[64:67], v[8:11], v[68:71]
    s_nop 4
    v_mov_b32_sdwa v48, v42 dst_sel:BYTE_0 dst_unused:UNUSED_PRESERVE src0_sel:BYTE_0
    v_mov_b32_sdwa v52, v42 dst_sel:BYTE_0 dst_unused:UNUSED_PRESERVE src0_sel:BYTE_0
    s_and_b32 exec_lo, s60, 0xf000f
    s_and_b32 exec_hi, s60, 0xf000f
    s_cmp_eq_u32 s56, 0
    s_cbranch_scc1 L_st_134
    buffer_store_dwordx4 v[48:51], v32, s[16:19], 0 offen
    buffer_store_dwordx4 v[52:55], v32, s[16:19], 0 offen offset:64
    s_mov_b32 exec_lo, 0x20001
    s_mov_b32 exec_hi, 0x80004
    v_mov_b32 v71, s47
    buffer_store_dwordx4 v[68:71], v33, s[16:19], 0 offen
L_st_135:
    s_mov_b64 exec, s[60:61]
    s_branch L_gr_131
L_role_132:
    s_waitcnt lgkmcnt(0)
    s_barrier
    ds_read_b128 v[4:7], v30 offset:12352
    ds_read_b128 v[8:11], v30 offset:12416
    s_waitcnt lgkmcnt(1)
    v_mfma_f32_16x16x32_bf16 v[48:51], v[12:15], v[4:7], 0
    v_mfma_f32_16x16x32_bf16 v[52:55], v[20:23], v[4:7], 0
    s_waitcnt lgkmcnt(0)
    v_mfma_f32_16x16x32_bf16 v[48:51], v[16:19], v[8:11], v[48:51]
    v_mfma_f32_16x16x32_bf16 v[52:55], v[24:27], v[8:11], v[52:55]
    s_nop 6
    v_mov_b32_sdwa v48, v42 dst_sel:BYTE_0 dst_unused:UNUSED_PRESERVE src0_sel:BYTE_0
    v_mov_b32_sdwa v52, v42 dst_sel:BYTE_0 dst_unused:UNUSED_PRESERVE src0_sel:BYTE_0
    s_and_b32 exec_lo, s60, 0xf000f
    s_and_b32 exec_hi, s60, 0xf000f
    s_cmp_eq_u32 s56, 0
    s_cbranch_scc1 L_st_137
    buffer_store_dwordx4 v[48:51], v32, s[16:19], 0 offen
    buffer_store_dwordx4 v[52:55], v32, s[16:19], 0 offen offset:64
L_st_138:
    s_mov_b64 exec, s[60:61]
L_gr_131:
    s_barrier
L_qwait:
    s_bitcmp1_b32 s57, 2
    s_cbranch_scc0 L_role_139
    v_mov_b32 v16, 0
    v_mov_b32 v17, 0
    s_mov_b32 exec_lo, 0x3ff03ff
    s_mov_b32 exec_hi, 0x3ff03ff
    buffer_load_dwordx4 v[16:19], v38, s[16:19], 0 offen sc1
    s_mov_b64 exec, -1
    v_mov_b32 v28, 0
    v_mov_b32 v29, 0
    v_mov_b32 v30, 0
    v_mov_b32 v31, 0
    v_mov_b32 v32, 0
    v_mov_b32 v33, 0
    v_mov_b32 v34, 0
    v_mov_b32 v35, 0
    v_mov_b32 v41, 0
    v_mov_b32 v42, 0
    v_mov_b32 v43, 0
    v_mov_b32 v44, 0
    v_mov_b32 v45, 0
    v_mov_b32 v46, 0
    v_mov_b32 v47, 0
    s_mul_i32 s62, s47, 0x01010101
    v_bfe_u32 v23, v0, 0, 2
    v_lshlrev_b32 v23, 3, v23
    v_lshrrev_b32 v23, v23, s62
    s_mov_b32 exec_lo, 0x3ff03ff
    s_mov_b32 exec_hi, 0x3ff03ff
    s_waitcnt vmcnt(0)
    v_cmp_ne_u32 vcc, s47, v19
    s_cbranch_vccz L_pb_141
L_pa_140:
    buffer_load_dwordx4 v[16:19], v38, s[16:19], 0 offen sc1
    s_sub_u32 s58, s58, 1
    s_waitcnt vmcnt(0)
    s_cbranch_scc1 L_end
    v_cmp_ne_u32 vcc, s47, v19
    s_cbranch_vccnz L_pa_140
L_pb_141:
    s_mov_b64 exec, -1
    buffer_load_dwordx4 v[4:7], v36, s[16:19], 0 offen sc1
    buffer_load_dwordx4 v[8:11], v36, s[16:19], s43 offen sc1
    buffer_load_dwordx4 v[12:15], v37, s[16:19], 0 offen sc1
    v_add_f32_dpp v16, v16, v16 quad_perm:[1,0,3,2] row_mask:0xf bank_mask:0xf
    v_add_f32_dpp v17, v17, v17 quad_perm:[1,0,3,2] row_mask:0xf bank_mask:0xf
    s_nop 0
    v_add_f32_dpp v16, v16, v16 quad_perm:[2,3,0,1] row_mask:0xf bank_mask:0xf
    v_add_f32_dpp v17, v17, v17 quad_perm:[2,3,0,1] row_mask:0xf bank_mask:0xf
    s_nop 0
    v_add_f32_dpp v16, v16, v16 row_half_mirror row_mask:0xf bank_mask:0xf
    v_add_f32_dpp v17, v17, v17 row_half_mirror row_mask:0xf bank_mask:0xf
    s_nop 0
    v_add_f32_dpp v16, v16, v16 row_mirror row_mask:0xf bank_mask:0xf
    v_add_f32_dpp v17, v17, v17 row_mirror row_mask:0xf bank_mask:0xf
    v_mul_f32 v17, s95, v17
    v_mul_f32 v16, s95, v16
    v_fma_f32 v21, -v17, v17, v16
    v_cvt_pk_bf16_f32 v20, 0, v17
    v_max_f32 v21, 0, v21
    v_cvt_pk_bf16_f32 v21, 0, v21
    v_add_f32 v21, s59, v21
    v_cvt_pk_bf16_f32 v21, 0, v21
    v_sqrt_f32 v21, v21
    s_nop 0
    v_cvt_pk_bf16_f32 v21, 0, v21
    v_rcp_f32 v22, v21
L_pw_142:
    s_waitcnt vmcnt(0)
    v_cmp_ne_u32_sdwa vcc, v12, v23 src0_sel:BYTE_0 src1_sel:BYTE_0
    v_add_f32 v5, v5, v9
    v_and_b32 v12, 0xffffff00, v12
    v_add_f32 v6, v6, v10
    v_cmp_ne_u32_sdwa s[62:63], v4, v23 src0_sel:BYTE_0 src1_sel:BYTE_0
    v_add_f32 v7, v7, v11
    v_and_b32 v4, 0xffffff00, v4
    v_add_f32 v6, v6, v14
    v_cmp_ne_u32_sdwa s[88:89], v8, v23 src0_sel:BYTE_0 src1_sel:BYTE_0
    v_add_f32 v5, v5, v13
    v_and_b32 v8, 0xffffff00, v8
    v_add_f32 v7, v7, v15
    v_add_f32 v4, v4, v8
    v_add_f32 v4, v4, v12
    s_nop 1
    v_permlane32_swap_b32 v4, v6
    v_permlane32_swap_b32 v5, v7
    v_add_f32 v4, v4, v6
    s_mov_b32 vcc_hi, 0
    v_add_f32 v5, v5, v7
    s_or_b64 vcc, vcc, s[62:63]
    s_nop 0
    v_permlane16_swap_b32 v4, v5
    s_or_b64 vcc, vcc, s[88:89]
    v_add_f32 v4, v4, v5
    v_fma_f32 v4, -v20, v40, v4
    v_mul_f32 v4, v4, v22
    v_cvt_pk_bf16_f32 v5, 0, v4
    ds_write_b16_d16_hi v39, v5 offset:16288
    s_cbranch_vccnz L_retry_143
    v_mov_b32 v36, 0
    v_mov_b32 v37, 0
    v_mov_b32 v38, 0
    v_mov_b32 v39, 0
    v_mov_b32 v40, 0
    s_mov_b32 s6, 1
    s_branch L_attn_bar
L_role_139:
    v_mov_b32 v28, 0
    v_mov_b32 v29, 0
    v_mov_b32 v30, 0
    v_mov_b32 v31, 0
    v_mov_b32 v32, 0
    v_mov_b32 v33, 0
    v_mov_b32 v34, 0
    v_mov_b32 v35, 0
    v_mov_b32 v36, 0
    v_mov_b32 v37, 0
    v_mov_b32 v38, 0
    v_mov_b32 v39, 0
    v_mov_b32 v40, 0
    v_mov_b32 v41, 0
    v_mov_b32 v42, 0
    v_mov_b32 v43, 0
    v_mov_b32 v44, 0
    v_mov_b32 v45, 0
    v_mov_b32 v46, 0
    v_mov_b32 v47, 0
    s_mov_b32 s6, 1
    s_branch L_attn_bar
L_idle:
    s_cmp_eq_u32 s6, 0
    s_cbranch_scc0 L_done
    s_bitcmp1_b32 s57, 2
    s_cbranch_scc0 L_role_145
    s_lshr_b32 s62, s5, 3
    s_mul_i32 s62, s62, 3
    s_and_b32 s63, s3, 3
    s_add_u32 s62, s62, s63
    s_lshr_b32 s63, s62, 2
    s_mul_i32 s63, s63, 10
    s_lshl_b32 s88, s4, 5
    s_add_u32 s63, s63, s88
    s_mul_i32 s63, s63, 5248
    s_add_u32 s63, s63, 1900544
    s_and_b32 s62, s62, 3
    s_lshl_b32 s62, s62, 8
    s_add_u32 s62, s62, s63
    s_add_u32 s62, s62, 4224
    v_lshrrev_b32 v1, 4, v0
    v_and_b32 v2, 15, v0
    v_mul_u32_u24 v36, 5248, v1
    v_lshl_add_u32 v36, v2, 4, v36
    v_add_u32 v36, s62, v36
    v_add_u32 v37, 41984, v36
    v_mov_b32 v3, 2146435072
    v_cmp_gt_u32 vcc, 32, v0
    s_nop 1
    v_cndmask_b32 v37, v3, v37, vcc
    v_lshlrev_b32 v40, 4, v2
    v_lshl_add_u32 v40, v1, 2, v40
    s_and_b32 s62, s3, 3
    s_lshl_b32 s62, s62, 8
    v_add_u32 v40, s62, v40
    s_mul_i32 s62, s47, 0x01010101
    v_bfe_u32 v24, v0, 0, 2
    v_lshlrev_b32 v24, 3, v24
    v_lshrrev_b32 v24, v24, s62
    buffer_load_dwordx4 v[12:15], v36, s[16:19], 0 offen sc1
    buffer_load_dwordx4 v[16:19], v36, s[16:19], s43 offen sc1
    buffer_load_dwordx4 v[20:23], v37, s[16:19], 0 offen sc1
L_pw_148:
    s_waitcnt vmcnt(0)
    v_cmp_ne_u32_sdwa vcc, v20, v24 src0_sel:BYTE_0 src1_sel:BYTE_0
    v_and_b32 v20, 0xffffff00, v20
    v_cmp_ne_u32_sdwa s[62:63], v12, v24 src0_sel:BYTE_0 src1_sel:BYTE_0
    v_and_b32 v12, 0xffffff00, v12
    v_cmp_ne_u32_sdwa s[88:89], v16, v24 src0_sel:BYTE_0 src1_sel:BYTE_0
    v_and_b32 v16, 0xffffff00, v16
    v_add_f32 v12, v12, v16
    v_add_f32 v13, v13, v17
    v_add_f32 v14, v14, v18
    v_add_f32 v15, v15, v19
    v_add_f32 v12, v12, v20
    v_add_f32 v13, v13, v21
    v_add_f32 v14, v14, v22
    v_add_f32 v15, v15, v23
    s_mov_b32 vcc_hi, 0
    s_or_b64 vcc, vcc, s[62:63]
    s_or_b64 vcc, vcc, s[88:89]
    v_permlane32_swap_b32 v12, v14
    v_permlane32_swap_b32 v13, v15
    v_add_f32 v12, v12, v14
    v_add_f32 v13, v13, v15
    s_nop 1
    v_permlane16_swap_b32 v12, v13
    v_add_f32 v12, v12, v13
    ds_write_b32 v40, v12 offset:16720
    s_cbranch_vccnz L_retry_149
L_role_145:
    s_add_u32 s47, s101, 1
    s_waitcnt lgkmcnt(0)
    v_lshrrev_b32 v1, 4, v0
    v_and_b32 v2, 3, v0
    v_lshlrev_b32 v2, 4, v2
    v_lshl_add_u32 v76, v1, 6, v2
    v_and_b32 v3, 0x40, v76
    v_add3_u32 v77, v3, v2, 64
    v_add_u32 v77, 192, v77
    v_bfe_u32 v2, v0, 2, 2
    v_mov_b32 v3, 384
    v_cmp_eq_u32 vcc, 0, v2
    s_nop 1
    v_cndmask_b32 v72, v3, v76, vcc
    v_cmp_eq_u32 vcc, 1, v2
    s_nop 1
    v_cndmask_b32 v73, v3, v76, vcc
    v_cmp_eq_u32 vcc, 2, v2
    s_nop 1
    v_cndmask_b32 v74, v3, v76, vcc
    v_cmp_eq_u32 vcc, 3, v2
    s_nop 1
    v_cndmask_b32 v75, v3, v76, vcc
    v_lshrrev_b32 v1, 5, v0
    v_cmp_eq_u32 vcc, v1, v2
    s_nop 1
    v_cndmask_b32 v76, v3, v77, vcc
    v_add_u32 v1, 2, v1
    v_cmp_eq_u32 vcc, v1, v2
    s_nop 1
    v_cndmask_b32 v77, v3, v77, vcc
    v_and_b32 v1, 1, v0
    v_mul_u32_u24 v78, 0xaaaa, v1
    v_add_u32 v78, 0x4444, v78
    v_and_b32 v1, 3, v0
    v_xor_b32 v2, 1, v1
    v_lshl_add_u32 v79, v2, 2, v1
    v_mul_u32_u24 v79, 0x1111, v79
    v_bfe_u32 v1, v0, 2, 1
    v_mul_u32_u24 v85, 0xffff, v1
    v_sub_u32 v84, 0xffff, v85
    s_mul_i32 s62, s3, 6144
    s_add_u32 s62, s62, 113792
    v_lshl_add_u32 v86, v0, 4, s62
    v_and_b32 v1, 7, v0
    v_lshlrev_b32 v1, 5, v1
    v_bfe_u32 v2, v0, 4, 1
    v_lshl_add_u32 v1, v2, 4, v1
    v_lshrrev_b32 v2, 5, v0
    v_mul_u32_u24 v2, 768, v2
    s_mul_i32 s62, s3, 1536
    v_add3_u32 v87, v1, v2, s62
    s_bitcmp1_b32 s57, 2
    s_cbranch_scc0 L_role_150
    s_bfe_u32 s89, s5, 0x20001
    s_lshl_b32 s91, s89, 10
    s_lshr_b32 s62, s5, 3
    s_mul_i32 s62, s62, 3
    s_and_b32 s63, s3, 3
    s_add_u32 s62, s62, s63
    s_lshr_b32 s63, s62, 2
    s_mul_i32 s63, s63, 10
    s_lshl_b32 s88, s4, 5
    s_add_u32 s63, s63, s88
    s_mul_i32 s63, s63, 5248
    s_add_u32 s63, s63, 1900544
    s_and_b32 s62, s62, 3
    s_lshl_b32 s62, s62, 8
    s_add_u32 s62, s62, s63
    s_add_u32 s62, s62, s91
    v_lshrrev_b32 v1, 4, v0
    v_and_b32 v2, 15, v0
    v_mul_u32_u24 v36, 5248, v1
    v_lshl_add_u32 v36, v2, 4, v36
    v_add_u32 v36, s62, v36
    v_add_u32 v37, 41984, v36
    v_mov_b32 v3, 2146435072
    v_cmp_gt_u32 vcc, 32, v0
    s_nop 1
    v_cndmask_b32 v37, v3, v37, vcc
    v_lshlrev_b32 v40, 4, v2
    v_lshl_add_u32 v40, v1, 2, v40
    s_and_b32 s62, s3, 3
    s_lshl_b32 s62, s62, 8
    v_add_u32 v40, s62, v40
    v_mul_u32_u24 v38, 5248, v2
    s_lshl_b32 s89, s89, 4
    s_add_u32 s89, s89, s63
    s_add_u32 s89, s89, 4096
    v_add_u32 v38, s89, v38
    v_cmp_gt_u32 vcc, 10, v2
    s_nop 1
    v_cndmask_b32 v38, v3, v38, vcc
    ds_read_b32 v40, v40 offset:16720
    v_bfe_u32 v1, v0, 3, 1
    v_lshlrev_b32 v39, 6, v1
    v_bfe_u32 v1, v0, 1, 1
    v_lshl_add_u32 v39, v1, 5, v39
    v_lshrrev_b32 v1, 5, v0
    v_lshl_add_u32 v39, v1, 4, v39
    v_bfe_u32 v1, v0, 2, 1
    v_lshl_add_u32 v39, v1, 3, v39
    v_and_b32 v1, 1, v0
    v_lshl_add_u32 v39, v1, 2, v39
    v_bfe_u32 v1, v0, 4, 1
    v_lshl_add_u32 v39, v1, 1, v39
    s_lshr_b32 s62, s62, 1
    v_add_u32 v39, s62, v39
L_role_150:
    s_waitcnt lgkmcnt(0)
    s_branch L_qwait
L_final:
    s_and_b32 s62, s5, 7
    s_cmp_eq_u32 s62, s4
    s_cbranch_scc0 L_done
    s_cmp_lt_u32 s5, 10
    s_cbranch_scc0 L_done
    s_branch L_ycommon
L_done:
L_end:
L_exit:
    s_endpgm
L_retry_54:
    s_sub_u32 s58, s58, 1
    s_cbranch_scc1 L_end
    buffer_load_dwordx4 v[56:59], v73, s[16:19], 0 offen sc1
    buffer_load_dwordx4 v[60:63], v73, s[16:19], 0 offen offset:896 sc1
    s_branch L_pw_53
L_retry_66:
    s_sub_u32 s58, s58, 1
    s_cbranch_scc1 L_end
    buffer_load_dwordx4 v[12:15], v36, s[16:19], 0 offen sc1
    buffer_load_dwordx4 v[16:19], v36, s[16:19], s43 offen sc1
    buffer_load_dwordx4 v[20:23], v37, s[16:19], 0 offen sc1
    s_branch L_pw_65
L_retry_76:
    s_sub_u32 s98, s98, 1
    s_cbranch_scc1 L_slow_77
    buffer_load_dwordx4 v[48:51], v28, s[16:19], 0 offen sc1
    buffer_load_dwordx4 v[52:55], v28, s[16:19], s40 offen sc1
    buffer_load_dwordx4 v[56:59], v28, s[16:19], s41 offen sc1
    s_branch L_pw_75
L_retry_102:
    s_sub_u32 s58, s58, 1
    s_cbranch_scc1 L_end
    buffer_load_dwordx4 v[52:55], v72, s[16:19], 0 offen sc1
    buffer_load_dwordx4 v[56:59], v72, s[16:19], s42 offen sc1
    buffer_load_dwordx4 v[60:63], v73, s[16:19], 0 offen sc1
    s_cmp_eq_u32 s6, 0
    s_cbranch_scc0 L_p0_107
    buffer_load_dword v44, v74, s[16:19], 0 offen offset:2048 sc1
    buffer_load_dword v45, v74, s[16:19], s42 offen offset:2048 sc1
    buffer_load_dword v46, v75, s[16:19], 0 offen offset:2048 sc1
L_p0_107:
    s_branch L_pw_101
L_retry_122:
    s_sub_u32 s98, s98, 1
    s_cbranch_scc1 L_slow_123
    buffer_load_dwordx4 v[48:51], v28, s[16:19], 0 offen sc1
    buffer_load_dwordx4 v[52:55], v28, s[16:19], s40 offen sc1
    buffer_load_dwordx4 v[56:59], v28, s[16:19], s41 offen sc1
    s_branch L_pw_121
L_retry_143:
    s_sub_u32 s58, s58, 1
    s_cbranch_scc1 L_end
    buffer_load_dwordx4 v[4:7], v36, s[16:19], 0 offen sc1
    buffer_load_dwordx4 v[8:11], v36, s[16:19], s43 offen sc1
    buffer_load_dwordx4 v[12:15], v37, s[16:19], 0 offen sc1
    s_branch L_pw_142
L_retry_149:
    s_sub_u32 s58, s58, 1
    s_cbranch_scc1 L_end
    buffer_load_dwordx4 v[12:15], v36, s[16:19], 0 offen sc1
    buffer_load_dwordx4 v[16:19], v36, s[16:19], s43 offen sc1
    buffer_load_dwordx4 v[20:23], v37, s[16:19], 0 offen sc1
    s_branch L_pw_148
    s_endpgm
L_tqr_5:
    s_sub_u32 s58, s58, 1
    s_cbranch_scc1 L_end
    s_branch L_tq_4
L_spr_8:
    s_sleep 2
    s_sub_u32 s58, s58, 1
    s_cbranch_scc1 L_end
    s_branch L_sp_7
L_spr_10:
    s_sleep 2
    s_sub_u32 s58, s58, 1
    s_cbranch_scc1 L_end
    s_branch L_sp_9
L_spr_16:
    s_sleep 2
    s_sub_u32 s58, s58, 1
    s_cbranch_scc1 L_end
    s_branch L_sp_15
L_spr_18:
    s_sleep 2
    s_sub_u32 s58, s58, 1
    s_cbranch_scc1 L_end
    s_branch L_sp_17
L_spr_23:
    s_sleep 2
    s_sub_u32 s58, s58, 1
    s_cbranch_scc1 L_end
    s_branch L_sp_22
L_chkr_30:
    s_sleep 8
    s_sub_u32 s58, s58, 1
    s_cbranch_scc1 L_end
    s_branch L_chk_29
L_spr_35:
    s_sleep 2
    s_sub_u32 s58, s58, 1
    s_cbranch_scc1 L_end
    s_branch L_sp_34
L_st_40:
    buffer_store_dword v48, v15, s[16:19], 0 offen sc1
    s_branch L_st_41
L_st_43:
    buffer_store_dwordx4 v[6:9], v16, s[16:19], 0 offen offset:768 sc1
    s_branch L_st_44
L_st_47:
    buffer_store_dwordx4 v[12:15], v1, s[16:19], s62 offen sc1
    s_branch L_st_48
L_slow_79:
    s_sub_u32 s58, s58, 1
    s_cbranch_scc1 L_end
L_slow_77:
    buffer_load_dwordx4 v[48:51], v28, s[16:19], 0 offen sc1
    buffer_load_dwordx4 v[52:55], v28, s[16:19], s40 offen sc1
    buffer_load_dwordx4 v[56:59], v28, s[16:19], s41 offen sc1
    s_waitcnt vmcnt(0)
    v_max_u32 v1, v48, v49
    v_max3_u32 v1, v1, v50, v51
    v_max3_u32 v1, v1, v52, v53
    v_max3_u32 v1, v1, v54, v55
    v_max3_u32 v1, v1, v56, v57
    v_max3_u32 v1, v1, v58, v59
    v_cmp_eq_u32 vcc, -1, v1
    s_cbranch_vccnz L_slow_79
    v_add_f32 v48, v48, v52
    v_add_f32 v49, v49, v53
    v_add_f32 v50, v50, v54
    v_add_f32 v51, v51, v55
    v_add_f32 v48, v48, v56
    v_add_f32 v50, v50, v58
    v_add_f32 v49, v49, v57
    v_add_f32 v51, v51, v59
    v_permlane32_swap_b32 v48, v50
    s_nop 0
    v_permlane32_swap_b32 v49, v51
    v_add_f32 v48, v48, v50
    v_add_f32 v49, v49, v51
    s_nop 1
    v_permlane16_swap_b32 v48, v49
    v_add_f32 v48, v48, v49
    s_nop 1
    v_add_f32_dpp v48, v48, v48 row_ror:8 row_mask:0xf bank_mask:0xf
    v_cvt_pk_bf16_f32 v49, 0, v48
    s_branch L_ok_78
L_st_87:
    buffer_store_dwordx4 v[48:51], v32, s[16:19], 0 offen sc1
    s_mov_b32 exec_lo, 0xffff0000
    buffer_store_dword v48, v34, s[16:19], 0 offen offset:1984 sc1
    s_mov_b64 exec, -1
    v_mov_b32_dpp v71, v70 row_newbcast:4 row_mask:0xf bank_mask:0xf
    v_mov_b32_sdwa v71, v85 dst_sel:BYTE_0 dst_unused:UNUSED_PRESERVE src0_sel:BYTE_0
    s_mov_b32 exec_lo, 0x20001
    s_mov_b32 exec_hi, 0x80004
    buffer_store_dwordx4 v[68:71], v33, s[16:19], 0 offen sc1
    s_branch L_st_88
L_st_90:
    buffer_store_dwordx4 v[48:51], v32, s[16:19], 0 offen sc1
    s_mov_b32 exec_lo, 0xffff0000
    buffer_store_dword v48, v34, s[16:19], 0 offen offset:1984 sc1
    s_branch L_st_91
L_st_94:
    buffer_store_dwordx4 v[48:51], v32, s[16:19], 0 offen sc1
    s_mov_b32 exec_lo, 0x20001
    s_mov_b32 exec_hi, 0x80004
    v_mov_b32 v71, v85
    buffer_store_dwordx4 v[68:71], v33, s[16:19], 0 offen sc1
    s_branch L_st_95
L_st_97:
    buffer_store_dwordx4 v[48:51], v32, s[16:19], 0 offen sc1
    s_branch L_st_98
L_slow_125:
    s_sub_u32 s58, s58, 1
    s_cbranch_scc1 L_end
L_slow_123:
    buffer_load_dwordx4 v[48:51], v28, s[16:19], 0 offen sc1
    buffer_load_dwordx4 v[52:55], v28, s[16:19], s40 offen sc1
    buffer_load_dwordx4 v[56:59], v28, s[16:19], s41 offen sc1
    s_waitcnt vmcnt(0)
    v_max_u32 v1, v48, v49
    v_max3_u32 v1, v1, v50, v51
    v_max3_u32 v1, v1, v52, v53
    v_max3_u32 v1, v1, v54, v55
    v_max3_u32 v1, v1, v56, v57
    v_max3_u32 v1, v1, v58, v59
    v_cmp_eq_u32 vcc, -1, v1
    s_cbranch_vccnz L_slow_125
    v_add_f32 v48, v48, v52
    v_add_f32 v49, v49, v53
    v_add_f32 v50, v50, v54
    v_add_f32 v51, v51, v55
    v_add_f32 v48, v48, v56
    v_add_f32 v50, v50, v58
    v_add_f32 v49, v49, v57
    v_add_f32 v51, v51, v59
    v_permlane32_swap_b32 v48, v50
    s_nop 0
    v_permlane32_swap_b32 v49, v51
    v_add_f32 v48, v48, v50
    v_add_f32 v49, v49, v51
    s_nop 1
    v_permlane16_swap_b32 v48, v49
    v_add_f32 v48, v48, v49
    s_nop 1
    v_add_f32_dpp v48, v48, v48 row_ror:8 row_mask:0xf bank_mask:0xf
    v_cvt_pk_bf16_f32 v49, 0, v48
    s_branch L_ok_124
L_st_134:
    buffer_store_dwordx4 v[48:51], v32, s[16:19], 0 offen sc1
    buffer_store_dwordx4 v[52:55], v32, s[16:19], 0 offen offset:64 sc1
    s_mov_b32 exec_lo, 0x20001
    s_mov_b32 exec_hi, 0x80004
    v_mov_b32 v71, s47
    buffer_store_dwordx4 v[68:71], v33, s[16:19], 0 offen sc1
    s_branch L_st_135
L_st_137:
    buffer_store_dwordx4 v[48:51], v32, s[16:19], 0 offen sc1
    buffer_store_dwordx4 v[52:55], v32, s[16:19], 0 offen offset:64 sc1
    s_branch L_st_138
.section .rodata,"a"
.p2align 6
.amdhsa_kernel interleave_layers__sliding_block_cached__moe_arch_mod__decode_kernel
  .amdhsa_next_free_vgpr 256
  .amdhsa_next_free_sgpr 102
  .amdhsa_accum_offset 160
  .amdhsa_group_segment_fixed_size 0
  .amdhsa_kernarg_size 104
  .amdhsa_user_sgpr_count 2
  .amdhsa_user_sgpr_kernarg_segment_ptr 1
  .amdhsa_system_sgpr_workgroup_id_x 1
  .amdhsa_float_denorm_mode_32 3
.end_amdhsa_kernel
```
